```python
import torch

def _softmax(x, axis=-1):
    return torch.softmax(x, dim=axis)
def _gelu(x):
    return torch.nn.functional.gelu(x, approximate="tanh")
def _silu(x):
    return torch.nn.functional.silu(x)
def _sigmoid(x):
    return torch.sigmoid(x)
def _layernorm(x, axis=-1, eps=1e-5):
    m = x.mean(dim=axis, keepdim=True)
    v = x.var(dim=axis, keepdim=True, unbiased=False)
    return (x - m) / torch.sqrt(v + eps)
def _scatter_add(tgt, idx, src, axis=0):
    return tgt.clone().index_add_(axis, idx, src)
def _segment_sum(src, seg, n):
    out = torch.zeros((n,) + src.shape[1:], dtype=src.dtype)
    return out.index_add_(0, seg, src)
def _pad(x, pw):
    flat = tuple(v for pair in reversed(pw) for v in pair)
    return torch.nn.functional.pad(x, flat)

kernel_name = 'parallel_sum__spectral_gfnet__glu_gated_bilinear__prompt'

def setup_inputs():

    _w = (lambda a: (lambda t: t.to(torch.bfloat16) if t.is_floating_point() else t)(torch.as_tensor(a)))
    def _A_setup():
        B, S, D = 1, 2048, 640
        Df = D // 2 + 1
        return {
            "x": _w((lambda *s: torch.randn(*s, dtype=torch.bfloat16) * 0.05)(B, S, D)),
            "w_r": _w((lambda *s: torch.randn(*s, dtype=torch.bfloat16) * 0.4)(S, Df) * 0.02),
            "w_i": _w((lambda *s: torch.randn(*s, dtype=torch.bfloat16) * 0.4)(S, Df) * 0.02),
        }
    _A_in = _A_setup()

    def _B_setup():
        B, S, D, F = 1, 2048, 640, 1536
        return {
            "x": _w((lambda *s: torch.randn(*s, dtype=torch.bfloat16) * 0.05)(B, S, D)),
            "w_gate": _w((lambda *s: torch.randn(*s, dtype=torch.bfloat16) * 0.2)(D, F) * (D ** -0.5)),
            "w_up": _w((lambda *s: torch.randn(*s, dtype=torch.bfloat16) * 0.2)(D, F) * (D ** -0.5)),
            "w_down": _w((lambda *s: torch.randn(*s, dtype=torch.bfloat16) * 0.2)(F, D) * (F ** -0.5)),
        }
    _B_in = _B_setup()

    return {
        "A_x": _A_in["x"],
        "A_w_r": _A_in["w_r"],
        "A_w_i": _A_in["w_i"],
        "B_x": _B_in["x"],
        "B_w_gate": _B_in["w_gate"],
        "B_w_up": _B_in["w_up"],
        "B_w_down": _B_in["w_down"],
    }

def reference(A_x, A_w_r, A_w_i, B_x, B_w_gate, B_w_up, B_w_down):
    def _A_ref(x, w_r, w_i):
        B, S, D = x.shape
        X = (lambda x, axes=(-2,-1): torch.fft.rfft2(x.float(), dim=axes))(x, axes=(-2, -1))
        W = w_r + 1j * w_i
        X = X * W
        y = (lambda x, s, axes=(-2,-1): torch.fft.irfft2(x, s=s, dim=axes).to(torch.bfloat16))(X, (S, D), axes=(-2, -1))
        return y

    def _B_ref(x, w_gate, w_up, w_down):
        g = torch.einsum("bsd,df->bsf", x, w_gate)
        u = torch.einsum("bsd,df->bsf", x, w_up)
        h = g * u
        return torch.einsum("bsf,fd->bsd", h, w_down)

    x = A_x
    xn = _layernorm(x, axis=-1)
    return x + _A_ref(xn, A_w_r, A_w_i) + _B_ref(xn, B_w_gate, B_w_up, B_w_down)
```

```asm
; @launch kernel=k1_kernel grid=(256,1,1) block=(512,1,1) lds=163840
; @launch kernel=k2_kernel grid=(256,1,1) block=(512,1,1) lds=163840
.amdgcn_target "amdgcn-amd-amdhsa--gfx950"
.text
.globl k1_kernel
.p2align 8
.type k1_kernel,@function
k1_kernel:
    s_cmp_ge_u32 s2, 256
    s_cbranch_scc1 K1_END
    s_getpc_b64 s[6:7]
K1_PCE:
    s_cmp_lt_u32 s2, 64
    s_cselect_b32 s5, K1_A - K1_PCE, 0
    v_lshl_add_u32 v1, v0, 7, s5
    v_cmp_gt_u32 vcc, 64, v0
    s_nop 1
    s_and_saveexec_b64 s[8:9], vcc
    s_cbranch_execz K1_NOEPF
    global_load_dword v253, v1, s[6:7]
K1_NOEPF:
    s_mov_b64 exec, -1
    s_load_dwordx16 s[16:31], s[0:1], 0
    s_load_dwordx4 s[32:35], s[0:1], 64
    v_lshrrev_b32 v1, 6, v0
    s_nop 0
    v_readfirstlane_b32 s4, v1
    s_cmp_lt_u32 s2, 64
    s_cbranch_scc1 K1_A
    s_sub_u32 s3, s2, 64
    v_and_b32 v1, 63, v0
    s_and_b32 s7, s3, 3
    s_mul_i32 s7, s7, 3
    s_lshr_b32 s8, s3, 6
    s_add_u32 s53, s7, s8
    s_lshl_b32 s54, s4, 10
    s_mov_b32 s56, 0
    s_mul_i32 s5, s4, 12288
    s_lshl_b32 s6, s53, 8
    s_add_u32 s5, s5, s6
    v_lshrrev_b32 v4, 4, v1
    v_mul_u32_u24 v2, 3072, v4
    v_lshlrev_b32 v3, 2, v4
    v_and_b32 v7, 15, v1
    v_xor_b32 v3, v3, v7
    v_lshlrev_b32 v3, 4, v3
    v_add3_u32 v7, v2, v3, s5
    s_and_b32 s7, s3, 4
    s_lshl_b32 s7, s7, 1
    s_bfe_u32 s8, s3, 0x30003
    s_add_u32 s52, s7, s8
    s_lshl_b32 s61, s4, 11
    s_mov_b32 s55, 0
    s_and_b32 s5, s4, 1
    s_lshl_b32 s5, s5, 10
    s_lshl_b32 s6, s52, 2
    s_add_u32 s5, s5, s6
    s_lshr_b32 s6, s4, 1
    s_add_u32 s5, s5, s6
    s_mul_i32 s5, s5, 1280
    v_lshrrev_b32 v2, 3, v1
    v_mul_u32_u24 v2, 81920, v2
    v_and_b32 v3, 7, v1
    v_xor_b32 v3, v3, v4
    v_lshlrev_b32 v3, 4, v3
    v_add3_u32 v5, v2, v3, s5
    v_xor_b32 v3, 64, v3
    s_add_u32 s5, s5, 655360
    v_add3_u32 v6, v2, v3, s5
    s_mov_b32 s38, 2621440
    s_mov_b32 s39, 0x00020000
    s_mov_b32 s42, 1966080
    s_mov_b32 s43, 0x00020000
    s_mov_b32 s46, 1966080
    s_mov_b32 s47, 0x00020000
    s_waitcnt lgkmcnt(0)
    s_mov_b64 s[36:37], s[16:17]
    s_mov_b64 s[40:41], s[24:25]
    s_mov_b64 s[44:45], s[26:27]
    s_bfe_u32 s5, s3, 0x20003
    s_cmp_eq_u32 s5, 1
    s_cbranch_scc1 G_O1
    s_cmp_eq_u32 s5, 2
    s_cbranch_scc1 G_O2
    s_add_u32 m0, s61, 0
    s_nop 0
    buffer_load_dwordx4 v5, s[36:39], s55 offen lds
    s_add_u32 m0, s61, 1024
    s_nop 0
    buffer_load_dwordx4 v6, s[36:39], s55 offen lds
    s_add_u32 m0, s54, 65536
    s_nop 0
    buffer_load_dwordx4 v7, s[40:43], s56 offen lds
    s_add_u32 m0, s54, 73728
    s_nop 0
    buffer_load_dwordx4 v7, s[44:47], s56 offen lds
    s_branch G_OD
G_O1:
    s_add_u32 m0, s54, 65536
    s_nop 0
    buffer_load_dwordx4 v7, s[40:43], s56 offen lds
    s_add_u32 m0, s54, 73728
    s_nop 0
    buffer_load_dwordx4 v7, s[44:47], s56 offen lds
    s_add_u32 m0, s61, 0
    s_nop 0
    buffer_load_dwordx4 v5, s[36:39], s55 offen lds
    s_add_u32 m0, s61, 1024
    s_nop 0
    buffer_load_dwordx4 v6, s[36:39], s55 offen lds
    s_branch G_OD
G_O2:
    s_add_u32 m0, s54, 73728
    s_nop 0
    buffer_load_dwordx4 v7, s[44:47], s56 offen lds
    s_add_u32 m0, s61, 0
    s_nop 0
    buffer_load_dwordx4 v5, s[36:39], s55 offen lds
    s_add_u32 m0, s61, 1024
    s_nop 0
    buffer_load_dwordx4 v6, s[36:39], s55 offen lds
    s_add_u32 m0, s54, 65536
    s_nop 0
    buffer_load_dwordx4 v7, s[40:43], s56 offen lds
G_OD:
    s_add_u32 s55, s55, 128
    s_add_u32 s56, s56, 98304
    s_lshr_b32 s58, s4, 2
    s_and_b32 s59, s4, 3
    s_cmp_eq_u32 s4, 7
    s_cbranch_scc0 K1_NOCPFG
    s_getpc_b64 s[6:7]
K1_PCG:
    s_sub_u32 s6, s6, K1_PCG - k1_kernel
    s_subb_u32 s7, s7, 0
    s_lshr_b32 s5, s2, 3
    s_lshl_b32 s5, s5, 11
    v_and_b32 v254, 15, v0
    v_lshl_add_u32 v254, v254, 7, s5
    v_min_u32 v254, CODE_END - k1_kernel - 4, v254
    s_mov_b64 exec, 0xffff
    global_load_dword v255, v254, s[6:7]
    s_mov_b64 exec, -1
K1_NOCPFG:
    s_lshr_b32 s6, s3, 3
    s_lshl_b32 s6, s6, 3
    s_add_u32 s6, s6, s4
    s_cmp_ge_u32 s6, 96
    s_cbranch_scc1 G_PFW
    s_lshr_b32 s7, s6, 4
    s_lshl_b32 s7, s7, 7
    s_and_b32 s8, s6, 15
    s_mul_i32 s8, s8, 163840
    s_add_u32 s7, s7, s8
    s_bfe_u32 s8, s3, 0x10002
    s_mul_i32 s8, s8, 40960
    s_add_u32 s7, s7, s8
    s_add_u32 s7, s7, 512
    v_and_b32 v2, 31, v1
    v_mul_u32_u24 v8, 1280, v2
    v_lshrrev_b32 v2, 5, v1
    v_mul_u32_u24 v2, 81920, v2
    v_add_u32 v8, v8, v2
    s_mov_b64 s[64:65], s[36:37]
    s_mov_b32 s66, 2621440
    s_cmp_lt_u32 s6, 32
    s_branch G_PFGO
G_PFW:
    s_sub_u32 s6, s6, 96
    s_bitcmp1_b32 s6, 0
    s_cselect_b32 s64, s44, s40
    s_cselect_b32 s65, s45, s41
    s_mov_b32 s66, 1966080
    s_lshr_b32 s6, s6, 1
    s_lshl_b32 s6, s6, 6
    v_add_u32 v2, s6, v1
    s_mov_b32 s7, 43691
    v_mul_u32_u24 v3, s7, v2
    v_lshrrev_b32 v3, 18, v3
    v_mul_u32_u24 v8, 6, v3
    v_sub_u32 v2, v2, v8
    v_mul_u32_u24 v3, 3072, v3
    v_lshl_add_u32 v8, v2, 7, v3
    s_and_b32 s7, s3, 3
    s_mul_i32 s7, s7, 768
    s_add_u32 s7, s7, 491520
    s_cmp_lt_u32 s6, 896
G_PFGO:
    s_mov_b32 s67, 0x00020000
    s_cselect_b32 s11, s7, 0x7fffffff
    s_cselect_b32 s12, 0x7fffffff, s7
    s_mov_b32 s48, s34
    s_mov_b32 s49, s35
    s_mov_b32 s50, 6422528
    s_mov_b32 s51, 0x00020000
    v_lshrrev_b32 v26, 5, v1
    v_and_b32 v27, 31, v1
    v_bfe_u32 v2, v1, 1, 3
    v_xor_b32 v2, v2, v26
    s_and_b32 s5, s59, 2
    v_xor_b32 v2, s5, v2
    v_lshlrev_b32 v2, 4, v2
    v_lshl_add_u32 v2, v27, 7, v2
    s_lshl_b32 s5, s58, 13
    s_and_b32 s6, s59, 1
    s_lshl_b32 s6, s6, 12
    s_add_u32 s5, s5, s6
    v_add_u32 v10, s5, v2
    v_xor_b32 v11, 32, v10
    v_xor_b32 v12, 64, v10
    v_xor_b32 v13, 0x60, v10
    v_xor_b32 v14, 0x1000, v10
    v_xor_b32 v15, 0x1000, v11
    v_xor_b32 v16, 0x1000, v12
    v_xor_b32 v17, 0x1000, v13
    v_bfe_u32 v2, v1, 2, 2
    v_lshl_add_u32 v3, v26, 3, v2
    v_lshlrev_b32 v3, 8, v3
    v_xor_b32 v2, s59, v2
    v_lshl_add_u32 v3, v2, 6, v3
    v_bfe_u32 v2, v1, 4, 1
    v_lshl_add_u32 v3, v2, 5, v3
    v_and_b32 v2, 3, v1
    v_lshl_add_u32 v3, v2, 3, v3
    s_lshr_b32 s5, s59, 1
    s_lshl_b32 s5, s5, 12
    s_lshl_b32 s6, s58, 13
    s_add_u32 s5, s5, s6
    s_add_u32 s5, s5, 65536
    v_add_u32 v18, s5, v3
    v_xor_b32 v20, 0x2000, v18
    v_xor_b32 v19, 0x1000, v18
    v_xor_b32 v21, 0x1000, v20
    v_add_u32 v22, 49152, v18
    v_add_u32 v23, 49152, v19
    v_add_u32 v24, 49152, v20
    v_add_u32 v25, 49152, v21
    s_mov_b32 s60, 0xffff0000
    v_mov_b32 v124, 0
    v_mov_b32 v125, 0
    v_mov_b32 v126, 0
    v_mov_b32 v127, 0
    v_lshrrev_b32 v2, 4, v1
    v_xor_b32 v2, v2, v1
    v_and_b32 v2, 1, v2
    v_cmp_eq_u32 vcc, 0, v2
    v_mov_b32 v3, 1065369472
    s_nop 0
    v_cndmask_b32 v136, 0, v3, vcc
    v_mov_b32 v137, v136
    v_mov_b32 v138, v136
    v_mov_b32 v139, v136
    s_add_u32 m0, s54, 81920
    s_nop 0
    buffer_load_dwordx4 v7, s[40:43], s56 offen lds
    s_add_u32 m0, s54, 90112
    s_nop 0
    buffer_load_dwordx4 v7, s[44:47], s56 offen lds
    s_add_u32 s56, s56, 98304
    buffer_load_dword v9, v8, s[64:67], s11 offen
    s_add_u32 m0, s61, 16384
    s_nop 0
    buffer_load_dwordx4 v5, s[36:39], s55 offen lds
    s_add_u32 m0, s61, 17408
    s_nop 0
    buffer_load_dwordx4 v6, s[36:39], s55 offen lds
    s_add_u32 s55, s55, 128
    s_add_u32 m0, s54, 98304
    s_nop 0
    buffer_load_dwordx4 v7, s[40:43], s56 offen lds
    s_add_u32 m0, s54, 106496
    s_nop 0
    buffer_load_dwordx4 v7, s[44:47], s56 offen lds
    s_add_u32 s56, s56, 98304
    s_waitcnt vmcnt(7)
    s_barrier
    s_waitcnt lgkmcnt(0)
    ds_read_b64_tr_b16 v[108:109], v18 offset:0
    ds_read_b64_tr_b16 v[110:111], v18 offset:1024
    ds_read_b128 v[92:95], v10 offset:0
    ds_read_b64_tr_b16 v[112:113], v20 offset:0
    ds_read_b64_tr_b16 v[114:115], v20 offset:1024
    ds_read_b128 v[96:99], v14 offset:0
    s_waitcnt lgkmcnt(3)
    v_mfma_f32_32x32x16_bf16 v[28:43], v[108:111], v[92:95], 0
    ds_read_b64_tr_b16 v[116:117], v19 offset:0
    ds_read_b64_tr_b16 v[118:119], v19 offset:1024
    ds_read_b128 v[100:103], v11 offset:0
    s_waitcnt lgkmcnt(3)
    v_mfma_f32_32x32x16_bf16 v[76:91], v[112:115], v[96:99], 0
    ds_read_b64_tr_b16 v[120:121], v21 offset:0
    ds_read_b64_tr_b16 v[122:123], v21 offset:1024
    ds_read_b128 v[104:107], v15 offset:0
    v_lshlrev_b32 v128, 16, v92
    v_and_b32 v129, s60, v92
    v_add_f32 v124, v124, v128
    v_add_f32 v125, v125, v129
    v_fmac_f32 v126, v128, v128
    v_fmac_f32 v127, v129, v129
    v_mfma_f32_32x32x16_bf16 v[44:59], v[112:115], v[92:95], 0
    v_lshlrev_b32 v130, 16, v93
    v_and_b32 v131, s60, v93
    v_add_f32 v124, v124, v130
    v_add_f32 v125, v125, v131
    v_fmac_f32 v126, v130, v130
    v_fmac_f32 v127, v131, v131
    s_add_u32 m0, s54, 114688
    s_nop 0
    buffer_load_dwordx4 v7, s[40:43], s56 offen lds
    v_mfma_f32_32x32x16_bf16 v[60:75], v[108:111], v[96:99], 0
    v_lshlrev_b32 v128, 16, v94
    v_and_b32 v129, s60, v94
    v_add_f32 v124, v124, v128
    v_add_f32 v125, v125, v129
    v_fmac_f32 v126, v128, v128
    v_fmac_f32 v127, v129, v129
    s_add_u32 m0, s54, 122880
    s_nop 0
    buffer_load_dwordx4 v7, s[44:47], s56 offen lds
    s_add_u32 s56, s56, 98304
    v_mfma_f32_16x16x32_bf16 v[132:135], v[108:111], v[136:139], 0
    v_lshlrev_b32 v130, 16, v95
    v_and_b32 v131, s60, v95
    v_add_f32 v124, v124, v130
    v_add_f32 v125, v125, v131
    v_fmac_f32 v126, v130, v130
    v_fmac_f32 v127, v131, v131
    s_add_u32 m0, s61, 32768
    s_nop 0
    buffer_load_dwordx4 v5, s[36:39], s55 offen lds
    s_waitcnt vmcnt(8)
    s_barrier
    s_waitcnt lgkmcnt(3)
    v_mfma_f32_32x32x16_bf16 v[28:43], v[116:119], v[100:103], v[28:43]
    ds_read_b64_tr_b16 v[108:109], v18 offset:16384
    ds_read_b64_tr_b16 v[110:111], v18 offset:17408
    ds_read_b128 v[92:95], v12 offset:0
    s_waitcnt lgkmcnt(3)
    v_mfma_f32_32x32x16_bf16 v[76:91], v[120:123], v[104:107], v[76:91]
    ds_read_b64_tr_b16 v[112:113], v20 offset:16384
    ds_read_b64_tr_b16 v[114:115], v20 offset:17408
    ds_read_b128 v[96:99], v16 offset:0
    v_mfma_f32_32x32x16_bf16 v[44:59], v[120:123], v[100:103], v[44:59]
    s_add_u32 m0, s61, 33792
    s_nop 0
    buffer_load_dwordx4 v6, s[36:39], s55 offen lds
    s_add_u32 s55, s55, 128
    v_mfma_f32_32x32x16_bf16 v[60:75], v[116:119], v[104:107], v[60:75]
    s_add_u32 m0, s54, 131072
    s_nop 0
    buffer_load_dwordx4 v7, s[40:43], s56 offen lds
    v_mfma_f32_16x16x32_bf16 v[132:135], v[116:119], v[136:139], v[132:135]
    s_add_u32 m0, s54, 139264
    s_nop 0
    buffer_load_dwordx4 v7, s[44:47], s56 offen lds
    s_add_u32 s56, s56, 98304
    s_waitcnt lgkmcnt(3)
    v_mfma_f32_32x32x16_bf16 v[28:43], v[108:111], v[92:95], v[28:43]
    ds_read_b64_tr_b16 v[116:117], v19 offset:16384
    ds_read_b64_tr_b16 v[118:119], v19 offset:17408
    ds_read_b128 v[100:103], v13 offset:0
    s_waitcnt lgkmcnt(3)
    v_mfma_f32_32x32x16_bf16 v[76:91], v[112:115], v[96:99], v[76:91]
    ds_read_b64_tr_b16 v[120:121], v21 offset:16384
    ds_read_b64_tr_b16 v[122:123], v21 offset:17408
    ds_read_b128 v[104:107], v17 offset:0
    v_lshlrev_b32 v128, 16, v92
    v_and_b32 v129, s60, v92
    v_add_f32 v124, v124, v128
    v_add_f32 v125, v125, v129
    v_fmac_f32 v126, v128, v128
    v_fmac_f32 v127, v129, v129
    v_mfma_f32_32x32x16_bf16 v[44:59], v[112:115], v[92:95], v[44:59]
    v_lshlrev_b32 v130, 16, v93
    v_and_b32 v131, s60, v93
    v_add_f32 v124, v124, v130
    v_add_f32 v125, v125, v131
    v_fmac_f32 v126, v130, v130
    v_fmac_f32 v127, v131, v131
    s_add_u32 m0, s54, 147456
    s_nop 0
    buffer_load_dwordx4 v7, s[40:43], s56 offen lds
    v_mfma_f32_32x32x16_bf16 v[60:75], v[108:111], v[96:99], v[60:75]
    v_lshlrev_b32 v128, 16, v94
    v_and_b32 v129, s60, v94
    v_add_f32 v124, v124, v128
    v_add_f32 v125, v125, v129
    v_fmac_f32 v126, v128, v128
    v_fmac_f32 v127, v129, v129
    s_add_u32 m0, s54, 155648
    s_nop 0
    buffer_load_dwordx4 v7, s[44:47], s56 offen lds
    s_add_u32 s56, s56, 98304
    v_mfma_f32_16x16x32_bf16 v[132:135], v[108:111], v[136:139], v[132:135]
    v_lshlrev_b32 v130, 16, v95
    v_and_b32 v131, s60, v95
    v_add_f32 v124, v124, v130
    v_add_f32 v125, v125, v131
    v_fmac_f32 v126, v130, v130
    v_fmac_f32 v127, v131, v131
    s_add_u32 m0, s61, 49152
    s_nop 0
    buffer_load_dwordx4 v5, s[36:39], s55 offen lds
    s_waitcnt vmcnt(9)
    s_barrier
    s_waitcnt lgkmcnt(3)
    v_mfma_f32_32x32x16_bf16 v[28:43], v[116:119], v[100:103], v[28:43]
    ds_read_b64_tr_b16 v[108:109], v18 offset:32768
    ds_read_b64_tr_b16 v[110:111], v18 offset:33792
    ds_read_b128 v[92:95], v10 offset:16384
    s_waitcnt lgkmcnt(3)
    v_mfma_f32_32x32x16_bf16 v[76:91], v[120:123], v[104:107], v[76:91]
    ds_read_b64_tr_b16 v[112:113], v20 offset:32768
    ds_read_b64_tr_b16 v[114:115], v20 offset:33792
    ds_read_b128 v[96:99], v14 offset:16384
    v_mfma_f32_32x32x16_bf16 v[44:59], v[120:123], v[100:103], v[44:59]
    s_add_u32 m0, s61, 50176
    s_nop 0
    buffer_load_dwordx4 v6, s[36:39], s55 offen lds
    s_add_u32 s55, s55, 128
    v_mfma_f32_32x32x16_bf16 v[60:75], v[116:119], v[104:107], v[60:75]
    s_add_u32 m0, s54, 65536
    s_nop 0
    buffer_load_dwordx4 v7, s[40:43], s56 offen lds
    v_mfma_f32_16x16x32_bf16 v[132:135], v[116:119], v[136:139], v[132:135]
    s_add_u32 m0, s54, 73728
    s_nop 0
    buffer_load_dwordx4 v7, s[44:47], s56 offen lds
    s_add_u32 s56, s56, 98304
    s_waitcnt lgkmcnt(3)
    v_mfma_f32_32x32x16_bf16 v[28:43], v[108:111], v[92:95], v[28:43]
    ds_read_b64_tr_b16 v[116:117], v19 offset:32768
    ds_read_b64_tr_b16 v[118:119], v19 offset:33792
    ds_read_b128 v[100:103], v11 offset:16384
    s_waitcnt lgkmcnt(3)
    v_mfma_f32_32x32x16_bf16 v[76:91], v[112:115], v[96:99], v[76:91]
    ds_read_b64_tr_b16 v[120:121], v21 offset:32768
    ds_read_b64_tr_b16 v[122:123], v21 offset:33792
    ds_read_b128 v[104:107], v15 offset:16384
    v_lshlrev_b32 v128, 16, v92
    v_and_b32 v129, s60, v92
    v_add_f32 v124, v124, v128
    v_add_f32 v125, v125, v129
    v_fmac_f32 v126, v128, v128
    v_fmac_f32 v127, v129, v129
    v_mfma_f32_32x32x16_bf16 v[44:59], v[112:115], v[92:95], v[44:59]
    v_lshlrev_b32 v130, 16, v93
    v_and_b32 v131, s60, v93
    v_add_f32 v124, v124, v130
    v_add_f32 v125, v125, v131
    v_fmac_f32 v126, v130, v130
    v_fmac_f32 v127, v131, v131
    v_mfma_f32_32x32x16_bf16 v[60:75], v[108:111], v[96:99], v[60:75]
    v_lshlrev_b32 v128, 16, v94
    v_and_b32 v129, s60, v94
    v_add_f32 v124, v124, v128
    v_add_f32 v125, v125, v129
    v_fmac_f32 v126, v128, v128
    v_fmac_f32 v127, v129, v129
    v_mfma_f32_16x16x32_bf16 v[132:135], v[108:111], v[136:139], v[132:135]
    v_lshlrev_b32 v130, 16, v95
    v_and_b32 v131, s60, v95
    v_add_f32 v124, v124, v130
    v_add_f32 v125, v125, v131
    v_fmac_f32 v126, v130, v130
    v_fmac_f32 v127, v131, v131
    s_waitcnt vmcnt(10)
    s_barrier
    s_waitcnt lgkmcnt(3)
    v_mfma_f32_32x32x16_bf16 v[28:43], v[116:119], v[100:103], v[28:43]
    ds_read_b64_tr_b16 v[108:109], v22 offset:0
    ds_read_b64_tr_b16 v[110:111], v22 offset:1024
    ds_read_b128 v[92:95], v12 offset:16384
    s_waitcnt lgkmcnt(3)
    v_mfma_f32_32x32x16_bf16 v[76:91], v[120:123], v[104:107], v[76:91]
    ds_read_b64_tr_b16 v[112:113], v24 offset:0
    ds_read_b64_tr_b16 v[114:115], v24 offset:1024
    ds_read_b128 v[96:99], v16 offset:16384
    v_mfma_f32_32x32x16_bf16 v[44:59], v[120:123], v[100:103], v[44:59]
    s_add_u32 m0, s54, 81920
    s_nop 0
    buffer_load_dwordx4 v7, s[40:43], s56 offen lds
    v_mfma_f32_32x32x16_bf16 v[60:75], v[116:119], v[104:107], v[60:75]
    s_add_u32 m0, s54, 90112
    s_nop 0
    buffer_load_dwordx4 v7, s[44:47], s56 offen lds
    s_add_u32 s56, s56, 98304
    v_mfma_f32_16x16x32_bf16 v[132:135], v[116:119], v[136:139], v[132:135]
    s_add_u32 m0, s61, 0
    s_nop 0
    buffer_load_dwordx4 v5, s[36:39], s55 offen lds
    buffer_load_dword v9, v8, s[64:67], s12 offen
    s_waitcnt lgkmcnt(3)
    v_mfma_f32_32x32x16_bf16 v[28:43], v[108:111], v[92:95], v[28:43]
    ds_read_b64_tr_b16 v[116:117], v23 offset:0
    ds_read_b64_tr_b16 v[118:119], v23 offset:1024
    ds_read_b128 v[100:103], v13 offset:16384
    s_waitcnt lgkmcnt(3)
    v_mfma_f32_32x32x16_bf16 v[76:91], v[112:115], v[96:99], v[76:91]
    ds_read_b64_tr_b16 v[120:121], v25 offset:0
    ds_read_b64_tr_b16 v[122:123], v25 offset:1024
    ds_read_b128 v[104:107], v17 offset:16384
    v_lshlrev_b32 v128, 16, v92
    v_and_b32 v129, s60, v92
    v_add_f32 v124, v124, v128
    v_add_f32 v125, v125, v129
    v_fmac_f32 v126, v128, v128
    v_fmac_f32 v127, v129, v129
    v_mfma_f32_32x32x16_bf16 v[44:59], v[112:115], v[92:95], v[44:59]
    v_lshlrev_b32 v130, 16, v93
    v_and_b32 v131, s60, v93
    v_add_f32 v124, v124, v130
    v_add_f32 v125, v125, v131
    v_fmac_f32 v126, v130, v130
    v_fmac_f32 v127, v131, v131
    s_add_u32 m0, s61, 1024
    s_nop 0
    buffer_load_dwordx4 v6, s[36:39], s55 offen lds
    s_add_u32 s55, s55, 128
    v_mfma_f32_32x32x16_bf16 v[60:75], v[108:111], v[96:99], v[60:75]
    v_lshlrev_b32 v128, 16, v94
    v_and_b32 v129, s60, v94
    v_add_f32 v124, v124, v128
    v_add_f32 v125, v125, v129
    v_fmac_f32 v126, v128, v128
    v_fmac_f32 v127, v129, v129
    v_mfma_f32_16x16x32_bf16 v[132:135], v[108:111], v[136:139], v[132:135]
    v_lshlrev_b32 v130, 16, v95
    v_and_b32 v131, s60, v95
    v_add_f32 v124, v124, v130
    v_add_f32 v125, v125, v131
    v_fmac_f32 v126, v130, v130
    v_fmac_f32 v127, v131, v131
    s_waitcnt vmcnt(11)
    s_barrier
    s_waitcnt lgkmcnt(3)
    v_mfma_f32_32x32x16_bf16 v[28:43], v[116:119], v[100:103], v[28:43]
    ds_read_b64_tr_b16 v[108:109], v22 offset:16384
    ds_read_b64_tr_b16 v[110:111], v22 offset:17408
    ds_read_b128 v[92:95], v10 offset:32768
    s_waitcnt lgkmcnt(3)
    v_mfma_f32_32x32x16_bf16 v[76:91], v[120:123], v[104:107], v[76:91]
    ds_read_b64_tr_b16 v[112:113], v24 offset:16384
    ds_read_b64_tr_b16 v[114:115], v24 offset:17408
    ds_read_b128 v[96:99], v14 offset:32768
    v_mfma_f32_32x32x16_bf16 v[44:59], v[120:123], v[100:103], v[44:59]
    s_add_u32 m0, s54, 98304
    s_nop 0
    buffer_load_dwordx4 v7, s[40:43], s56 offen lds
    v_mfma_f32_32x32x16_bf16 v[60:75], v[116:119], v[104:107], v[60:75]
    s_add_u32 m0, s54, 106496
    s_nop 0
    buffer_load_dwordx4 v7, s[44:47], s56 offen lds
    s_add_u32 s56, s56, 98304
    v_mfma_f32_16x16x32_bf16 v[132:135], v[116:119], v[136:139], v[132:135]
    s_waitcnt lgkmcnt(3)
    v_mfma_f32_32x32x16_bf16 v[28:43], v[108:111], v[92:95], v[28:43]
    ds_read_b64_tr_b16 v[116:117], v23 offset:16384
    ds_read_b64_tr_b16 v[118:119], v23 offset:17408
    ds_read_b128 v[100:103], v11 offset:32768
    s_waitcnt lgkmcnt(3)
    v_mfma_f32_32x32x16_bf16 v[76:91], v[112:115], v[96:99], v[76:91]
    ds_read_b64_tr_b16 v[120:121], v25 offset:16384
    ds_read_b64_tr_b16 v[122:123], v25 offset:17408
    ds_read_b128 v[104:107], v15 offset:32768
    v_lshlrev_b32 v128, 16, v92
    v_and_b32 v129, s60, v92
    v_add_f32 v124, v124, v128
    v_add_f32 v125, v125, v129
    v_fmac_f32 v126, v128, v128
    v_fmac_f32 v127, v129, v129
    v_mfma_f32_32x32x16_bf16 v[44:59], v[112:115], v[92:95], v[44:59]
    v_lshlrev_b32 v130, 16, v93
    v_and_b32 v131, s60, v93
    v_add_f32 v124, v124, v130
    v_add_f32 v125, v125, v131
    v_fmac_f32 v126, v130, v130
    v_fmac_f32 v127, v131, v131
    v_mfma_f32_32x32x16_bf16 v[60:75], v[108:111], v[96:99], v[60:75]
    v_lshlrev_b32 v128, 16, v94
    v_and_b32 v129, s60, v94
    v_add_f32 v124, v124, v128
    v_add_f32 v125, v125, v129
    v_fmac_f32 v126, v128, v128
    v_fmac_f32 v127, v129, v129
    v_mfma_f32_16x16x32_bf16 v[132:135], v[108:111], v[136:139], v[132:135]
    v_lshlrev_b32 v130, 16, v95
    v_and_b32 v131, s60, v95
    v_add_f32 v124, v124, v130
    v_add_f32 v125, v125, v131
    v_fmac_f32 v126, v130, v130
    v_fmac_f32 v127, v131, v131
    s_waitcnt vmcnt(11)
    s_barrier
    s_waitcnt lgkmcnt(3)
    v_mfma_f32_32x32x16_bf16 v[28:43], v[116:119], v[100:103], v[28:43]
    ds_read_b64_tr_b16 v[108:109], v22 offset:32768
    ds_read_b64_tr_b16 v[110:111], v22 offset:33792
    ds_read_b128 v[92:95], v12 offset:32768
    s_waitcnt lgkmcnt(3)
    v_mfma_f32_32x32x16_bf16 v[76:91], v[120:123], v[104:107], v[76:91]
    ds_read_b64_tr_b16 v[112:113], v24 offset:32768
    ds_read_b64_tr_b16 v[114:115], v24 offset:33792
    ds_read_b128 v[96:99], v16 offset:32768
    v_mfma_f32_32x32x16_bf16 v[44:59], v[120:123], v[100:103], v[44:59]
    s_add_u32 m0, s54, 114688
    s_nop 0
    buffer_load_dwordx4 v7, s[40:43], s56 offen lds
    v_mfma_f32_32x32x16_bf16 v[60:75], v[116:119], v[104:107], v[60:75]
    s_add_u32 m0, s54, 122880
    s_nop 0
    buffer_load_dwordx4 v7, s[44:47], s56 offen lds
    s_add_u32 s56, s56, 98304
    v_mfma_f32_16x16x32_bf16 v[132:135], v[116:119], v[136:139], v[132:135]
    s_add_u32 m0, s61, 16384
    s_nop 0
    buffer_load_dwordx4 v5, s[36:39], s55 offen lds
    s_waitcnt lgkmcnt(3)
    v_mfma_f32_32x32x16_bf16 v[28:43], v[108:111], v[92:95], v[28:43]
    ds_read_b64_tr_b16 v[116:117], v23 offset:32768
    ds_read_b64_tr_b16 v[118:119], v23 offset:33792
    ds_read_b128 v[100:103], v13 offset:32768
    s_waitcnt lgkmcnt(3)
    v_mfma_f32_32x32x16_bf16 v[76:91], v[112:115], v[96:99], v[76:91]
    ds_read_b64_tr_b16 v[120:121], v25 offset:32768
    ds_read_b64_tr_b16 v[122:123], v25 offset:33792
    ds_read_b128 v[104:107], v17 offset:32768
    v_lshlrev_b32 v128, 16, v92
    v_and_b32 v129, s60, v92
    v_add_f32 v124, v124, v128
    v_add_f32 v125, v125, v129
    v_fmac_f32 v126, v128, v128
    v_fmac_f32 v127, v129, v129
    v_mfma_f32_32x32x16_bf16 v[44:59], v[112:115], v[92:95], v[44:59]
    v_lshlrev_b32 v130, 16, v93
    v_and_b32 v131, s60, v93
    v_add_f32 v124, v124, v130
    v_add_f32 v125, v125, v131
    v_fmac_f32 v126, v130, v130
    v_fmac_f32 v127, v131, v131
    s_add_u32 m0, s61, 17408
    s_nop 0
    buffer_load_dwordx4 v6, s[36:39], s55 offen lds
    s_add_u32 s55, s55, 128
    v_mfma_f32_32x32x16_bf16 v[60:75], v[108:111], v[96:99], v[60:75]
    v_lshlrev_b32 v128, 16, v94
    v_and_b32 v129, s60, v94
    v_add_f32 v124, v124, v128
    v_add_f32 v125, v125, v129
    v_fmac_f32 v126, v128, v128
    v_fmac_f32 v127, v129, v129
    v_mfma_f32_16x16x32_bf16 v[132:135], v[108:111], v[136:139], v[132:135]
    v_lshlrev_b32 v130, 16, v95
    v_and_b32 v131, s60, v95
    v_add_f32 v124, v124, v130
    v_add_f32 v125, v125, v131
    v_fmac_f32 v126, v130, v130
    v_fmac_f32 v127, v131, v131
    s_waitcnt vmcnt(11)
    s_barrier
    s_waitcnt lgkmcnt(3)
    v_mfma_f32_32x32x16_bf16 v[28:43], v[116:119], v[100:103], v[28:43]
    ds_read_b64_tr_b16 v[108:109], v18 offset:0
    ds_read_b64_tr_b16 v[110:111], v18 offset:1024
    ds_read_b128 v[92:95], v10 offset:49152
    s_waitcnt lgkmcnt(3)
    v_mfma_f32_32x32x16_bf16 v[76:91], v[120:123], v[104:107], v[76:91]
    ds_read_b64_tr_b16 v[112:113], v20 offset:0
    ds_read_b64_tr_b16 v[114:115], v20 offset:1024
    ds_read_b128 v[96:99], v14 offset:49152
    v_mfma_f32_32x32x16_bf16 v[44:59], v[120:123], v[100:103], v[44:59]
    s_add_u32 m0, s54, 131072
    s_nop 0
    buffer_load_dwordx4 v7, s[40:43], s56 offen lds
    v_mfma_f32_32x32x16_bf16 v[60:75], v[116:119], v[104:107], v[60:75]
    s_add_u32 m0, s54, 139264
    s_nop 0
    buffer_load_dwordx4 v7, s[44:47], s56 offen lds
    s_add_u32 s56, s56, 98304
    v_mfma_f32_16x16x32_bf16 v[132:135], v[116:119], v[136:139], v[132:135]
    s_waitcnt lgkmcnt(3)
    v_mfma_f32_32x32x16_bf16 v[28:43], v[108:111], v[92:95], v[28:43]
    ds_read_b64_tr_b16 v[116:117], v19 offset:0
    ds_read_b64_tr_b16 v[118:119], v19 offset:1024
    ds_read_b128 v[100:103], v11 offset:49152
    s_waitcnt lgkmcnt(3)
    v_mfma_f32_32x32x16_bf16 v[76:91], v[112:115], v[96:99], v[76:91]
    ds_read_b64_tr_b16 v[120:121], v21 offset:0
    ds_read_b64_tr_b16 v[122:123], v21 offset:1024
    ds_read_b128 v[104:107], v15 offset:49152
    v_lshlrev_b32 v128, 16, v92
    v_and_b32 v129, s60, v92
    v_add_f32 v124, v124, v128
    v_add_f32 v125, v125, v129
    v_fmac_f32 v126, v128, v128
    v_fmac_f32 v127, v129, v129
    v_mfma_f32_32x32x16_bf16 v[44:59], v[112:115], v[92:95], v[44:59]
    v_lshlrev_b32 v130, 16, v93
    v_and_b32 v131, s60, v93
    v_add_f32 v124, v124, v130
    v_add_f32 v125, v125, v131
    v_fmac_f32 v126, v130, v130
    v_fmac_f32 v127, v131, v131
    v_mfma_f32_32x32x16_bf16 v[60:75], v[108:111], v[96:99], v[60:75]
    v_lshlrev_b32 v128, 16, v94
    v_and_b32 v129, s60, v94
    v_add_f32 v124, v124, v128
    v_add_f32 v125, v125, v129
    v_fmac_f32 v126, v128, v128
    v_fmac_f32 v127, v129, v129
    v_mfma_f32_16x16x32_bf16 v[132:135], v[108:111], v[136:139], v[132:135]
    v_lshlrev_b32 v130, 16, v95
    v_and_b32 v131, s60, v95
    v_add_f32 v124, v124, v130
    v_add_f32 v125, v125, v131
    v_fmac_f32 v126, v130, v130
    v_fmac_f32 v127, v131, v131
    s_waitcnt vmcnt(11)
    s_barrier
    s_waitcnt lgkmcnt(3)
    v_mfma_f32_32x32x16_bf16 v[28:43], v[116:119], v[100:103], v[28:43]
    ds_read_b64_tr_b16 v[108:109], v18 offset:16384
    ds_read_b64_tr_b16 v[110:111], v18 offset:17408
    ds_read_b128 v[92:95], v12 offset:49152
    s_waitcnt lgkmcnt(3)
    v_mfma_f32_32x32x16_bf16 v[76:91], v[120:123], v[104:107], v[76:91]
    ds_read_b64_tr_b16 v[112:113], v20 offset:16384
    ds_read_b64_tr_b16 v[114:115], v20 offset:17408
    ds_read_b128 v[96:99], v16 offset:49152
    v_mfma_f32_32x32x16_bf16 v[44:59], v[120:123], v[100:103], v[44:59]
    s_add_u32 m0, s54, 147456
    s_nop 0
    buffer_load_dwordx4 v7, s[40:43], s56 offen lds
    v_mfma_f32_32x32x16_bf16 v[60:75], v[116:119], v[104:107], v[60:75]
    s_add_u32 m0, s54, 155648
    s_nop 0
    buffer_load_dwordx4 v7, s[44:47], s56 offen lds
    s_add_u32 s56, s56, 98304
    v_mfma_f32_16x16x32_bf16 v[132:135], v[116:119], v[136:139], v[132:135]
    s_add_u32 m0, s61, 32768
    s_nop 0
    buffer_load_dwordx4 v5, s[36:39], s55 offen lds
    s_mov_b32 s64, s28
    s_mov_b32 s65, s29
    s_mov_b32 s66, 1966080
    s_mov_b32 s67, 0x00020000
    s_and_b32 s5, s3, 7
    s_mul_i32 s5, s5, 6
    s_lshr_b32 s14, s3, 5
    s_add_u32 s14, s14, s5
    s_bfe_u32 s15, s3, 0x20003
    s_lshl_b32 s5, s14, 3
    s_add_u32 s5, s5, s4
    s_mul_i32 s5, s5, 5120
    s_mul_i32 s6, s15, 160
    s_add_u32 s5, s5, s6
    s_mul_i32 s6, s4, 1280
    s_mov_b32 s7, 3277
    v_add_u32 v2, 0, v1
    v_mul_u32_u24 v3, s7, v2
    v_lshrrev_b32 v3, 15, v3
    v_mul_u32_u24 v3, 480, v3
    v_lshl_add_u32 v3, v2, 4, v3
    buffer_load_dwordx4 v[140:143], v3, s[64:67], s5 offen
    v_add_u32 v2, 64, v1
    v_mul_u32_u24 v3, s7, v2
    v_lshrrev_b32 v3, 15, v3
    v_mul_u32_u24 v3, 480, v3
    v_lshl_add_u32 v3, v2, 4, v3
    s_mov_b64 exec, 0xffff
    buffer_load_dwordx4 v[144:147], v3, s[64:67], s5 offen
    s_mov_b64 exec, -1
    s_waitcnt lgkmcnt(3)
    v_mfma_f32_32x32x16_bf16 v[28:43], v[108:111], v[92:95], v[28:43]
    ds_read_b64_tr_b16 v[116:117], v19 offset:16384
    ds_read_b64_tr_b16 v[118:119], v19 offset:17408
    ds_read_b128 v[100:103], v13 offset:49152
    s_waitcnt lgkmcnt(3)
    v_mfma_f32_32x32x16_bf16 v[76:91], v[112:115], v[96:99], v[76:91]
    ds_read_b64_tr_b16 v[120:121], v21 offset:16384
    ds_read_b64_tr_b16 v[122:123], v21 offset:17408
    ds_read_b128 v[104:107], v17 offset:49152
    v_lshlrev_b32 v128, 16, v92
    v_and_b32 v129, s60, v92
    v_add_f32 v124, v124, v128
    v_add_f32 v125, v125, v129
    v_fmac_f32 v126, v128, v128
    v_fmac_f32 v127, v129, v129
    v_mfma_f32_32x32x16_bf16 v[44:59], v[112:115], v[92:95], v[44:59]
    v_lshlrev_b32 v130, 16, v93
    v_and_b32 v131, s60, v93
    v_add_f32 v124, v124, v130
    v_add_f32 v125, v125, v131
    v_fmac_f32 v126, v130, v130
    v_fmac_f32 v127, v131, v131
    s_add_u32 m0, s61, 33792
    s_nop 0
    buffer_load_dwordx4 v6, s[36:39], s55 offen lds
    s_add_u32 s55, s55, 128
    v_mfma_f32_32x32x16_bf16 v[60:75], v[108:111], v[96:99], v[60:75]
    v_lshlrev_b32 v128, 16, v94
    v_and_b32 v129, s60, v94
    v_add_f32 v124, v124, v128
    v_add_f32 v125, v125, v129
    v_fmac_f32 v126, v128, v128
    v_fmac_f32 v127, v129, v129
    v_mfma_f32_16x16x32_bf16 v[132:135], v[108:111], v[136:139], v[132:135]
    v_lshlrev_b32 v130, 16, v95
    v_and_b32 v131, s60, v95
    v_add_f32 v124, v124, v130
    v_add_f32 v125, v125, v131
    v_fmac_f32 v126, v130, v130
    v_fmac_f32 v127, v131, v131
    s_waitcnt vmcnt(12)
    s_barrier
    s_waitcnt lgkmcnt(3)
    v_mfma_f32_32x32x16_bf16 v[28:43], v[116:119], v[100:103], v[28:43]
    ds_read_b64_tr_b16 v[108:109], v18 offset:32768
    ds_read_b64_tr_b16 v[110:111], v18 offset:33792
    ds_read_b128 v[92:95], v10 offset:0
    s_waitcnt lgkmcnt(3)
    v_mfma_f32_32x32x16_bf16 v[76:91], v[120:123], v[104:107], v[76:91]
    ds_read_b64_tr_b16 v[112:113], v20 offset:32768
    ds_read_b64_tr_b16 v[114:115], v20 offset:33792
    ds_read_b128 v[96:99], v14 offset:0
    v_mfma_f32_32x32x16_bf16 v[44:59], v[120:123], v[100:103], v[44:59]
    s_add_u32 m0, s54, 65536
    s_nop 0
    buffer_load_dwordx4 v7, s[40:43], s56 offen lds
    v_mfma_f32_32x32x16_bf16 v[60:75], v[116:119], v[104:107], v[60:75]
    s_add_u32 m0, s54, 73728
    s_nop 0
    buffer_load_dwordx4 v7, s[44:47], s56 offen lds
    s_add_u32 s56, s56, 98304
    v_mfma_f32_16x16x32_bf16 v[132:135], v[116:119], v[136:139], v[132:135]
    s_waitcnt lgkmcnt(3)
    v_mfma_f32_32x32x16_bf16 v[28:43], v[108:111], v[92:95], v[28:43]
    ds_read_b64_tr_b16 v[116:117], v19 offset:32768
    ds_read_b64_tr_b16 v[118:119], v19 offset:33792
    ds_read_b128 v[100:103], v11 offset:0
    s_waitcnt lgkmcnt(3)
    v_mfma_f32_32x32x16_bf16 v[76:91], v[112:115], v[96:99], v[76:91]
    ds_read_b64_tr_b16 v[120:121], v21 offset:32768
    ds_read_b64_tr_b16 v[122:123], v21 offset:33792
    ds_read_b128 v[104:107], v15 offset:0
    v_lshlrev_b32 v128, 16, v92
    v_and_b32 v129, s60, v92
    v_add_f32 v124, v124, v128
    v_add_f32 v125, v125, v129
    v_fmac_f32 v126, v128, v128
    v_fmac_f32 v127, v129, v129
    v_mfma_f32_32x32x16_bf16 v[44:59], v[112:115], v[92:95], v[44:59]
    v_lshlrev_b32 v130, 16, v93
    v_and_b32 v131, s60, v93
    v_add_f32 v124, v124, v130
    v_add_f32 v125, v125, v131
    v_fmac_f32 v126, v130, v130
    v_fmac_f32 v127, v131, v131
    v_mfma_f32_32x32x16_bf16 v[60:75], v[108:111], v[96:99], v[60:75]
    v_lshlrev_b32 v128, 16, v94
    v_and_b32 v129, s60, v94
    v_add_f32 v124, v124, v128
    v_add_f32 v125, v125, v129
    v_fmac_f32 v126, v128, v128
    v_fmac_f32 v127, v129, v129
    v_mfma_f32_16x16x32_bf16 v[132:135], v[108:111], v[136:139], v[132:135]
    v_lshlrev_b32 v130, 16, v95
    v_and_b32 v131, s60, v95
    v_add_f32 v124, v124, v130
    v_add_f32 v125, v125, v131
    v_fmac_f32 v126, v130, v130
    v_fmac_f32 v127, v131, v131
    s_waitcnt vmcnt(12)
    s_barrier
    s_waitcnt lgkmcnt(3)
    v_mfma_f32_32x32x16_bf16 v[28:43], v[116:119], v[100:103], v[28:43]
    ds_read_b64_tr_b16 v[108:109], v22 offset:0
    ds_read_b64_tr_b16 v[110:111], v22 offset:1024
    ds_read_b128 v[92:95], v12 offset:0
    s_waitcnt lgkmcnt(3)
    v_mfma_f32_32x32x16_bf16 v[76:91], v[120:123], v[104:107], v[76:91]
    ds_read_b64_tr_b16 v[112:113], v24 offset:0
    ds_read_b64_tr_b16 v[114:115], v24 offset:1024
    ds_read_b128 v[96:99], v16 offset:0
    v_mfma_f32_32x32x16_bf16 v[44:59], v[120:123], v[100:103], v[44:59]
    s_add_u32 m0, s54, 81920
    s_nop 0
    buffer_load_dwordx4 v7, s[40:43], s56 offen lds
    v_mfma_f32_32x32x16_bf16 v[60:75], v[116:119], v[104:107], v[60:75]
    s_add_u32 m0, s54, 90112
    s_nop 0
    buffer_load_dwordx4 v7, s[44:47], s56 offen lds
    s_add_u32 s56, s56, 98304
    v_mfma_f32_16x16x32_bf16 v[132:135], v[116:119], v[136:139], v[132:135]
    s_add_u32 m0, s61, 49152
    s_nop 0
    buffer_load_dwordx4 v5, s[36:39], s55 offen lds
    s_add_u32 s68, s34, 16777216
    s_addc_u32 s69, s35, 0
    s_mov_b32 s70, 1966080
    s_mov_b32 s71, 0x00020000
    v_bfe_u32 v3, v1, 2, 3
    v_lshl_add_u32 v2, v26, 4, v3
    v_mul_u32_u24 v2, 320, v2
    v_and_b32 v3, 3, v1
    s_cmp_ge_u32 s4, 5
    s_cselect_b32 s5, 5, 0
    s_cselect_b32 s6, 80, 0
    s_cselect_b32 s13, 245760, 0
    s_add_u32 s6, s6, 98304
    s_sub_u32 s5, s4, s5
    s_lshl_b32 s7, s5, 5
    v_lshl_add_u32 v4, v3, 3, s7
    v_cmp_lt_u32 vcc, 79, v4
    v_add_u32 v148, 80, v4
    s_nop 0
    v_cndmask_b32 v4, v4, v148, vcc
    v_add3_u32 v148, v4, v2, s6
    s_lshl_b32 s5, s5, 10
    s_add_u32 s5, s5, s13
    s_mul_i32 s6, s15, 491520
    s_add_u32 s5, s5, s6
    s_mul_i32 s6, s14, 5120
    s_add_u32 s62, s5, s6
    s_and_b32 s12, s4, 1
    s_add_u32 s12, s12, 8
    s_cmp_ge_u32 s12, 5
    s_cselect_b32 s5, 5, 0
    s_cselect_b32 s6, 80, 0
    s_cselect_b32 s13, 245760, 0
    s_add_u32 s6, s6, 98304
    s_sub_u32 s5, s12, s5
    s_lshl_b32 s7, s5, 5
    v_lshl_add_u32 v4, v3, 3, s7
    v_cmp_lt_u32 vcc, 79, v4
    v_add_u32 v149, 80, v4
    s_nop 0
    v_cndmask_b32 v4, v4, v149, vcc
    v_add3_u32 v149, v4, v2, s6
    s_lshl_b32 s5, s5, 10
    s_add_u32 s5, s5, s13
    s_mul_i32 s6, s15, 491520
    s_add_u32 s5, s5, s6
    s_mul_i32 s6, s14, 5120
    s_add_u32 s63, s5, s6
    v_lshlrev_b32 v150, 4, v1
    s_waitcnt lgkmcnt(3)
    v_mfma_f32_32x32x16_bf16 v[28:43], v[108:111], v[92:95], v[28:43]
    ds_read_b64_tr_b16 v[116:117], v23 offset:0
    ds_read_b64_tr_b16 v[118:119], v23 offset:1024
    ds_read_b128 v[100:103], v13 offset:0
    s_waitcnt lgkmcnt(3)
    v_mfma_f32_32x32x16_bf16 v[76:91], v[112:115], v[96:99], v[76:91]
    ds_read_b64_tr_b16 v[120:121], v25 offset:0
    ds_read_b64_tr_b16 v[122:123], v25 offset:1024
    ds_read_b128 v[104:107], v17 offset:0
    v_lshlrev_b32 v128, 16, v92
    v_and_b32 v129, s60, v92
    v_add_f32 v124, v124, v128
    v_add_f32 v125, v125, v129
    v_fmac_f32 v126, v128, v128
    v_fmac_f32 v127, v129, v129
    v_mfma_f32_32x32x16_bf16 v[44:59], v[112:115], v[92:95], v[44:59]
    v_lshlrev_b32 v130, 16, v93
    v_and_b32 v131, s60, v93
    v_add_f32 v124, v124, v130
    v_add_f32 v125, v125, v131
    v_fmac_f32 v126, v130, v130
    v_fmac_f32 v127, v131, v131
    s_add_u32 m0, s61, 50176
    s_nop 0
    buffer_load_dwordx4 v6, s[36:39], s55 offen lds
    s_add_u32 s55, s55, 128
    v_mfma_f32_32x32x16_bf16 v[60:75], v[108:111], v[96:99], v[60:75]
    v_lshlrev_b32 v128, 16, v94
    v_and_b32 v129, s60, v94
    v_add_f32 v124, v124, v128
    v_add_f32 v125, v125, v129
    v_fmac_f32 v126, v128, v128
    v_fmac_f32 v127, v129, v129
    v_mfma_f32_16x16x32_bf16 v[132:135], v[108:111], v[136:139], v[132:135]
    v_lshlrev_b32 v130, 16, v95
    v_and_b32 v131, s60, v95
    v_add_f32 v124, v124, v130
    v_add_f32 v125, v125, v131
    v_fmac_f32 v126, v130, v130
    v_fmac_f32 v127, v131, v131
    s_waitcnt vmcnt(12)
    s_barrier
    s_waitcnt lgkmcnt(3)
    v_mfma_f32_32x32x16_bf16 v[28:43], v[116:119], v[100:103], v[28:43]
    ds_read_b64_tr_b16 v[108:109], v22 offset:16384
    ds_read_b64_tr_b16 v[110:111], v22 offset:17408
    ds_read_b128 v[92:95], v10 offset:16384
    s_waitcnt lgkmcnt(3)
    v_mfma_f32_32x32x16_bf16 v[76:91], v[120:123], v[104:107], v[76:91]
    ds_read_b64_tr_b16 v[112:113], v24 offset:16384
    ds_read_b64_tr_b16 v[114:115], v24 offset:17408
    ds_read_b128 v[96:99], v14 offset:16384
    v_mfma_f32_32x32x16_bf16 v[44:59], v[120:123], v[100:103], v[44:59]
    s_add_u32 m0, s54, 98304
    s_nop 0
    buffer_load_dwordx4 v7, s[40:43], s56 offen lds
    v_mfma_f32_32x32x16_bf16 v[60:75], v[116:119], v[104:107], v[60:75]
    s_add_u32 m0, s54, 106496
    s_nop 0
    buffer_load_dwordx4 v7, s[44:47], s56 offen lds
    s_add_u32 s56, s56, 98304
    v_mfma_f32_16x16x32_bf16 v[132:135], v[116:119], v[136:139], v[132:135]
    s_waitcnt lgkmcnt(3)
    v_mfma_f32_32x32x16_bf16 v[28:43], v[108:111], v[92:95], v[28:43]
    ds_read_b64_tr_b16 v[116:117], v23 offset:16384
    ds_read_b64_tr_b16 v[118:119], v23 offset:17408
    ds_read_b128 v[100:103], v11 offset:16384
    s_waitcnt lgkmcnt(3)
    v_mfma_f32_32x32x16_bf16 v[76:91], v[112:115], v[96:99], v[76:91]
    ds_read_b64_tr_b16 v[120:121], v25 offset:16384
    ds_read_b64_tr_b16 v[122:123], v25 offset:17408
    ds_read_b128 v[104:107], v15 offset:16384
    v_lshlrev_b32 v128, 16, v92
    v_and_b32 v129, s60, v92
    v_add_f32 v124, v124, v128
    v_add_f32 v125, v125, v129
    v_fmac_f32 v126, v128, v128
    v_fmac_f32 v127, v129, v129
    v_mfma_f32_32x32x16_bf16 v[44:59], v[112:115], v[92:95], v[44:59]
    v_lshlrev_b32 v130, 16, v93
    v_and_b32 v131, s60, v93
    v_add_f32 v124, v124, v130
    v_add_f32 v125, v125, v131
    v_fmac_f32 v126, v130, v130
    v_fmac_f32 v127, v131, v131
    v_mfma_f32_32x32x16_bf16 v[60:75], v[108:111], v[96:99], v[60:75]
    v_lshlrev_b32 v128, 16, v94
    v_and_b32 v129, s60, v94
    v_add_f32 v124, v124, v128
    v_add_f32 v125, v125, v129
    v_fmac_f32 v126, v128, v128
    v_fmac_f32 v127, v129, v129
    v_mfma_f32_16x16x32_bf16 v[132:135], v[108:111], v[136:139], v[132:135]
    v_lshlrev_b32 v130, 16, v95
    v_and_b32 v131, s60, v95
    v_add_f32 v124, v124, v130
    v_add_f32 v125, v125, v131
    v_fmac_f32 v126, v130, v130
    v_fmac_f32 v127, v131, v131
    s_waitcnt vmcnt(12)
    s_barrier
    s_waitcnt lgkmcnt(3)
    v_mfma_f32_32x32x16_bf16 v[28:43], v[116:119], v[100:103], v[28:43]
    ds_read_b64_tr_b16 v[108:109], v22 offset:32768
    ds_read_b64_tr_b16 v[110:111], v22 offset:33792
    ds_read_b128 v[92:95], v12 offset:16384
    s_waitcnt lgkmcnt(3)
    v_mfma_f32_32x32x16_bf16 v[76:91], v[120:123], v[104:107], v[76:91]
    ds_read_b64_tr_b16 v[112:113], v24 offset:32768
    ds_read_b64_tr_b16 v[114:115], v24 offset:33792
    ds_read_b128 v[96:99], v16 offset:16384
    v_mfma_f32_32x32x16_bf16 v[44:59], v[120:123], v[100:103], v[44:59]
    s_add_u32 m0, s54, 114688
    s_nop 0
    buffer_load_dwordx4 v7, s[40:43], s56 offen lds
    v_mfma_f32_32x32x16_bf16 v[60:75], v[116:119], v[104:107], v[60:75]
    s_add_u32 m0, s54, 122880
    s_nop 0
    buffer_load_dwordx4 v7, s[44:47], s56 offen lds
    s_add_u32 s56, s56, 98304
    v_mfma_f32_16x16x32_bf16 v[132:135], v[116:119], v[136:139], v[132:135]
    s_add_u32 m0, s61, 0
    s_nop 0
    buffer_load_dwordx4 v5, s[36:39], s55 offen lds
    s_lshl_b32 s5, s58, 10
    s_and_b32 s6, s59, 1
    s_lshl_b32 s6, s6, 9
    s_add_u32 s5, s5, s6
    s_add_u32 s5, s5, 122880
    s_lshr_b32 s7, s59, 1
    s_lshl_b32 s7, s7, 8
    v_lshl_add_u32 v152, v27, 3, s5
    v_add_u32 v151, s7, v152
    v_xor_b32 v153, 0x200, v152
    s_lshl_b32 s6, s58, 9
    s_lshl_b32 s7, s59, 7
    s_add_u32 s6, s6, s7
    s_add_u32 s6, s6, 126976
    v_and_b32 v4, 1, v1
    v_lshl_add_u32 v4, v4, 6, s6
    v_and_b32 v2, 48, v1
    v_add_u32 v154, v4, v2
    v_lshl_add_u32 v155, v26, 4, s6
    v_xor_b32 v156, 0x200, v155
    s_lshl_b32 s5, s52, 2
    s_lshl_b32 s6, s58, 1
    s_add_u32 s5, s5, s6
    s_and_b32 s6, s59, 1
    s_add_u32 s9, s5, s6
    s_xor_b32 s10, s9, 1
    s_mul_i32 s9, s9, 100352
    s_mul_i32 s10, s10, 100352
    s_lshl_b32 s5, s53, 2
    s_add_u32 s5, s5, s59
    s_lshl_b32 s5, s5, 10
    v_bfe_u32 v2, v1, 4, 1
    v_mul_u32_u24 v2, 50176, v2
    v_lshl_add_u32 v2, v26, 8, v2
    v_and_b32 v157, 15, v1
    v_lshl_add_u32 v157, v157, 4, v2
    v_add_u32 v157, s5, v157
    s_waitcnt lgkmcnt(3)
    v_mfma_f32_32x32x16_bf16 v[28:43], v[108:111], v[92:95], v[28:43]
    ds_read_b64_tr_b16 v[116:117], v23 offset:32768
    ds_read_b64_tr_b16 v[118:119], v23 offset:33792
    ds_read_b128 v[100:103], v13 offset:16384
    s_waitcnt lgkmcnt(3)
    v_mfma_f32_32x32x16_bf16 v[76:91], v[112:115], v[96:99], v[76:91]
    ds_read_b64_tr_b16 v[120:121], v25 offset:32768
    ds_read_b64_tr_b16 v[122:123], v25 offset:33792
    ds_read_b128 v[104:107], v17 offset:16384
    v_lshlrev_b32 v128, 16, v92
    v_and_b32 v129, s60, v92
    v_add_f32 v124, v124, v128
    v_add_f32 v125, v125, v129
    v_fmac_f32 v126, v128, v128
    v_fmac_f32 v127, v129, v129
    v_mfma_f32_32x32x16_bf16 v[44:59], v[112:115], v[92:95], v[44:59]
    v_lshlrev_b32 v130, 16, v93
    v_and_b32 v131, s60, v93
    v_add_f32 v124, v124, v130
    v_add_f32 v125, v125, v131
    v_fmac_f32 v126, v130, v130
    v_fmac_f32 v127, v131, v131
    s_add_u32 m0, s61, 1024
    s_nop 0
    buffer_load_dwordx4 v6, s[36:39], s55 offen lds
    s_add_u32 s55, s55, 128
    v_mfma_f32_32x32x16_bf16 v[60:75], v[108:111], v[96:99], v[60:75]
    v_lshlrev_b32 v128, 16, v94
    v_and_b32 v129, s60, v94
    v_add_f32 v124, v124, v128
    v_add_f32 v125, v125, v129
    v_fmac_f32 v126, v128, v128
    v_fmac_f32 v127, v129, v129
    v_mfma_f32_16x16x32_bf16 v[132:135], v[108:111], v[136:139], v[132:135]
    v_lshlrev_b32 v130, 16, v95
    v_and_b32 v131, s60, v95
    v_add_f32 v124, v124, v130
    v_add_f32 v125, v125, v131
    v_fmac_f32 v126, v130, v130
    v_fmac_f32 v127, v131, v131
    s_waitcnt vmcnt(10)
    s_barrier
    s_waitcnt lgkmcnt(3)
    v_mfma_f32_32x32x16_bf16 v[28:43], v[116:119], v[100:103], v[28:43]
    ds_read_b64_tr_b16 v[108:109], v18 offset:0
    ds_read_b64_tr_b16 v[110:111], v18 offset:1024
    ds_read_b128 v[92:95], v10 offset:32768
    s_waitcnt lgkmcnt(3)
    v_mfma_f32_32x32x16_bf16 v[76:91], v[120:123], v[104:107], v[76:91]
    ds_read_b64_tr_b16 v[112:113], v20 offset:0
    ds_read_b64_tr_b16 v[114:115], v20 offset:1024
    ds_read_b128 v[96:99], v14 offset:32768
    v_mfma_f32_32x32x16_bf16 v[44:59], v[120:123], v[100:103], v[44:59]
    s_add_u32 m0, s54, 131072
    s_nop 0
    buffer_load_dwordx4 v7, s[40:43], s56 offen lds
    v_mfma_f32_32x32x16_bf16 v[60:75], v[116:119], v[104:107], v[60:75]
    s_add_u32 m0, s54, 139264
    s_nop 0
    buffer_load_dwordx4 v7, s[44:47], s56 offen lds
    s_add_u32 s56, s56, 98304
    v_mfma_f32_16x16x32_bf16 v[132:135], v[116:119], v[136:139], v[132:135]
    s_waitcnt lgkmcnt(3)
    v_mfma_f32_32x32x16_bf16 v[28:43], v[108:111], v[92:95], v[28:43]
    ds_read_b64_tr_b16 v[116:117], v19 offset:0
    ds_read_b64_tr_b16 v[118:119], v19 offset:1024
    ds_read_b128 v[100:103], v11 offset:32768
    s_waitcnt lgkmcnt(3)
    v_mfma_f32_32x32x16_bf16 v[76:91], v[112:115], v[96:99], v[76:91]
    ds_read_b64_tr_b16 v[120:121], v21 offset:0
    ds_read_b64_tr_b16 v[122:123], v21 offset:1024
    ds_read_b128 v[104:107], v15 offset:32768
    v_lshlrev_b32 v128, 16, v92
    v_and_b32 v129, s60, v92
    v_add_f32 v124, v124, v128
    v_add_f32 v125, v125, v129
    v_fmac_f32 v126, v128, v128
    v_fmac_f32 v127, v129, v129
    v_mfma_f32_32x32x16_bf16 v[44:59], v[112:115], v[92:95], v[44:59]
    v_lshlrev_b32 v130, 16, v93
    v_and_b32 v131, s60, v93
    v_add_f32 v124, v124, v130
    v_add_f32 v125, v125, v131
    v_fmac_f32 v126, v130, v130
    v_fmac_f32 v127, v131, v131
    v_mfma_f32_32x32x16_bf16 v[60:75], v[108:111], v[96:99], v[60:75]
    v_lshlrev_b32 v128, 16, v94
    v_and_b32 v129, s60, v94
    v_add_f32 v124, v124, v128
    v_add_f32 v125, v125, v129
    v_fmac_f32 v126, v128, v128
    v_fmac_f32 v127, v129, v129
    v_mfma_f32_16x16x32_bf16 v[132:135], v[108:111], v[136:139], v[132:135]
    v_lshlrev_b32 v130, 16, v95
    v_and_b32 v131, s60, v95
    v_add_f32 v124, v124, v130
    v_add_f32 v125, v125, v131
    v_fmac_f32 v126, v130, v130
    v_fmac_f32 v127, v131, v131
    s_waitcnt vmcnt(10)
    s_barrier
    s_waitcnt lgkmcnt(3)
    v_mfma_f32_32x32x16_bf16 v[28:43], v[116:119], v[100:103], v[28:43]
    ds_read_b64_tr_b16 v[108:109], v18 offset:16384
    ds_read_b64_tr_b16 v[110:111], v18 offset:17408
    ds_read_b128 v[92:95], v12 offset:32768
    s_waitcnt lgkmcnt(3)
    v_mfma_f32_32x32x16_bf16 v[76:91], v[120:123], v[104:107], v[76:91]
    ds_read_b64_tr_b16 v[112:113], v20 offset:16384
    ds_read_b64_tr_b16 v[114:115], v20 offset:17408
    ds_read_b128 v[96:99], v16 offset:32768
    v_mfma_f32_32x32x16_bf16 v[44:59], v[120:123], v[100:103], v[44:59]
    s_add_u32 m0, s54, 147456
    s_nop 0
    buffer_load_dwordx4 v7, s[40:43], s56 offen lds
    v_mfma_f32_32x32x16_bf16 v[60:75], v[116:119], v[104:107], v[60:75]
    s_add_u32 m0, s54, 155648
    s_nop 0
    buffer_load_dwordx4 v7, s[44:47], s56 offen lds
    s_add_u32 s56, s56, 98304
    v_mfma_f32_16x16x32_bf16 v[132:135], v[116:119], v[136:139], v[132:135]
    s_add_u32 m0, s61, 16384
    s_nop 0
    buffer_load_dwordx4 v5, s[36:39], s55 offen lds
    s_waitcnt lgkmcnt(3)
    v_mfma_f32_32x32x16_bf16 v[28:43], v[108:111], v[92:95], v[28:43]
    ds_read_b64_tr_b16 v[116:117], v19 offset:16384
    ds_read_b64_tr_b16 v[118:119], v19 offset:17408
    ds_read_b128 v[100:103], v13 offset:32768
    s_waitcnt lgkmcnt(3)
    v_mfma_f32_32x32x16_bf16 v[76:91], v[112:115], v[96:99], v[76:91]
    ds_read_b64_tr_b16 v[120:121], v21 offset:16384
    ds_read_b64_tr_b16 v[122:123], v21 offset:17408
    ds_read_b128 v[104:107], v17 offset:32768
    v_lshlrev_b32 v128, 16, v92
    v_and_b32 v129, s60, v92
    v_add_f32 v124, v124, v128
    v_add_f32 v125, v125, v129
    v_fmac_f32 v126, v128, v128
    v_fmac_f32 v127, v129, v129
    v_mfma_f32_32x32x16_bf16 v[44:59], v[112:115], v[92:95], v[44:59]
    v_lshlrev_b32 v130, 16, v93
    v_and_b32 v131, s60, v93
    v_add_f32 v124, v124, v130
    v_add_f32 v125, v125, v131
    v_fmac_f32 v126, v130, v130
    v_fmac_f32 v127, v131, v131
    s_add_u32 m0, s61, 17408
    s_nop 0
    buffer_load_dwordx4 v6, s[36:39], s55 offen lds
    s_add_u32 s55, s55, 128
    v_mfma_f32_32x32x16_bf16 v[60:75], v[108:111], v[96:99], v[60:75]
    v_lshlrev_b32 v128, 16, v94
    v_and_b32 v129, s60, v94
    v_add_f32 v124, v124, v128
    v_add_f32 v125, v125, v129
    v_fmac_f32 v126, v128, v128
    v_fmac_f32 v127, v129, v129
    v_mfma_f32_16x16x32_bf16 v[132:135], v[108:111], v[136:139], v[132:135]
    v_lshlrev_b32 v130, 16, v95
    v_and_b32 v131, s60, v95
    v_add_f32 v124, v124, v130
    v_add_f32 v125, v125, v131
    v_fmac_f32 v126, v130, v130
    v_fmac_f32 v127, v131, v131
    s_waitcnt vmcnt(10)
    s_barrier
    s_waitcnt lgkmcnt(3)
    v_mfma_f32_32x32x16_bf16 v[28:43], v[116:119], v[100:103], v[28:43]
    ds_read_b64_tr_b16 v[108:109], v18 offset:32768
    ds_read_b64_tr_b16 v[110:111], v18 offset:33792
    ds_read_b128 v[92:95], v10 offset:49152
    s_waitcnt lgkmcnt(3)
    v_mfma_f32_32x32x16_bf16 v[76:91], v[120:123], v[104:107], v[76:91]
    ds_read_b64_tr_b16 v[112:113], v20 offset:32768
    ds_read_b64_tr_b16 v[114:115], v20 offset:33792
    ds_read_b128 v[96:99], v14 offset:49152
    v_mfma_f32_32x32x16_bf16 v[44:59], v[120:123], v[100:103], v[44:59]
    s_add_u32 m0, s54, 65536
    s_nop 0
    buffer_load_dwordx4 v7, s[40:43], s56 offen lds
    v_mfma_f32_32x32x16_bf16 v[60:75], v[116:119], v[104:107], v[60:75]
    s_add_u32 m0, s54, 73728
    s_nop 0
    buffer_load_dwordx4 v7, s[44:47], s56 offen lds
    s_add_u32 s56, s56, 98304
    v_mfma_f32_16x16x32_bf16 v[132:135], v[116:119], v[136:139], v[132:135]
    s_waitcnt lgkmcnt(3)
    v_mfma_f32_32x32x16_bf16 v[28:43], v[108:111], v[92:95], v[28:43]
    ds_read_b64_tr_b16 v[116:117], v19 offset:32768
    ds_read_b64_tr_b16 v[118:119], v19 offset:33792
    ds_read_b128 v[100:103], v11 offset:49152
    s_waitcnt lgkmcnt(3)
    v_mfma_f32_32x32x16_bf16 v[76:91], v[112:115], v[96:99], v[76:91]
    ds_read_b64_tr_b16 v[120:121], v21 offset:32768
    ds_read_b64_tr_b16 v[122:123], v21 offset:33792
    ds_read_b128 v[104:107], v15 offset:49152
    v_lshlrev_b32 v128, 16, v92
    v_and_b32 v129, s60, v92
    v_add_f32 v124, v124, v128
    v_add_f32 v125, v125, v129
    v_fmac_f32 v126, v128, v128
    v_fmac_f32 v127, v129, v129
    v_mfma_f32_32x32x16_bf16 v[44:59], v[112:115], v[92:95], v[44:59]
    v_lshlrev_b32 v130, 16, v93
    v_and_b32 v131, s60, v93
    v_add_f32 v124, v124, v130
    v_add_f32 v125, v125, v131
    v_fmac_f32 v126, v130, v130
    v_fmac_f32 v127, v131, v131
    v_mfma_f32_32x32x16_bf16 v[60:75], v[108:111], v[96:99], v[60:75]
    v_lshlrev_b32 v128, 16, v94
    v_and_b32 v129, s60, v94
    v_add_f32 v124, v124, v128
    v_add_f32 v125, v125, v129
    v_fmac_f32 v126, v128, v128
    v_fmac_f32 v127, v129, v129
    v_mfma_f32_16x16x32_bf16 v[132:135], v[108:111], v[136:139], v[132:135]
    v_lshlrev_b32 v130, 16, v95
    v_and_b32 v131, s60, v95
    v_add_f32 v124, v124, v130
    v_add_f32 v125, v125, v131
    v_fmac_f32 v126, v130, v130
    v_fmac_f32 v127, v131, v131
    s_waitcnt vmcnt(10)
    s_barrier
    s_waitcnt lgkmcnt(3)
    v_mfma_f32_32x32x16_bf16 v[28:43], v[116:119], v[100:103], v[28:43]
    ds_read_b64_tr_b16 v[108:109], v22 offset:0
    ds_read_b64_tr_b16 v[110:111], v22 offset:1024
    ds_read_b128 v[92:95], v12 offset:49152
    s_waitcnt lgkmcnt(3)
    v_mfma_f32_32x32x16_bf16 v[76:91], v[120:123], v[104:107], v[76:91]
    ds_read_b64_tr_b16 v[112:113], v24 offset:0
    ds_read_b64_tr_b16 v[114:115], v24 offset:1024
    ds_read_b128 v[96:99], v16 offset:49152
    v_mfma_f32_32x32x16_bf16 v[44:59], v[120:123], v[100:103], v[44:59]
    s_add_u32 m0, s54, 81920
    s_nop 0
    buffer_load_dwordx4 v7, s[40:43], s56 offen lds
    v_mfma_f32_32x32x16_bf16 v[60:75], v[116:119], v[104:107], v[60:75]
    s_add_u32 m0, s54, 90112
    s_nop 0
    buffer_load_dwordx4 v7, s[44:47], s56 offen lds
    s_add_u32 s56, s56, 98304
    v_mfma_f32_16x16x32_bf16 v[132:135], v[116:119], v[136:139], v[132:135]
    s_waitcnt lgkmcnt(3)
    v_mfma_f32_32x32x16_bf16 v[28:43], v[108:111], v[92:95], v[28:43]
    ds_read_b64_tr_b16 v[116:117], v23 offset:0
    ds_read_b64_tr_b16 v[118:119], v23 offset:1024
    ds_read_b128 v[100:103], v13 offset:49152
    s_waitcnt lgkmcnt(3)
    v_mfma_f32_32x32x16_bf16 v[76:91], v[112:115], v[96:99], v[76:91]
    ds_read_b64_tr_b16 v[120:121], v25 offset:0
    ds_read_b64_tr_b16 v[122:123], v25 offset:1024
    ds_read_b128 v[104:107], v17 offset:49152
    v_lshlrev_b32 v128, 16, v92
    v_and_b32 v129, s60, v92
    v_add_f32 v124, v124, v128
    v_add_f32 v125, v125, v129
    v_fmac_f32 v126, v128, v128
    v_fmac_f32 v127, v129, v129
    v_mfma_f32_32x32x16_bf16 v[44:59], v[112:115], v[92:95], v[44:59]
    v_lshlrev_b32 v130, 16, v93
    v_and_b32 v131, s60, v93
    v_add_f32 v124, v124, v130
    v_add_f32 v125, v125, v131
    v_fmac_f32 v126, v130, v130
    v_fmac_f32 v127, v131, v131
    v_mfma_f32_32x32x16_bf16 v[60:75], v[108:111], v[96:99], v[60:75]
    v_lshlrev_b32 v128, 16, v94
    v_and_b32 v129, s60, v94
    v_add_f32 v124, v124, v128
    v_add_f32 v125, v125, v129
    v_fmac_f32 v126, v128, v128
    v_fmac_f32 v127, v129, v129
    v_mfma_f32_16x16x32_bf16 v[132:135], v[108:111], v[136:139], v[132:135]
    v_lshlrev_b32 v130, 16, v95
    v_and_b32 v131, s60, v95
    v_add_f32 v124, v124, v130
    v_add_f32 v125, v125, v131
    v_fmac_f32 v126, v130, v130
    v_fmac_f32 v127, v131, v131
    s_waitcnt vmcnt(8)
    s_barrier
    s_waitcnt lgkmcnt(3)
    v_mfma_f32_32x32x16_bf16 v[28:43], v[116:119], v[100:103], v[28:43]
    ds_read_b64_tr_b16 v[108:109], v22 offset:16384
    ds_read_b64_tr_b16 v[110:111], v22 offset:17408
    ds_read_b128 v[92:95], v10 offset:0
    s_waitcnt lgkmcnt(3)
    v_mfma_f32_32x32x16_bf16 v[76:91], v[120:123], v[104:107], v[76:91]
    ds_read_b64_tr_b16 v[112:113], v24 offset:16384
    ds_read_b64_tr_b16 v[114:115], v24 offset:17408
    ds_read_b128 v[96:99], v14 offset:0
    v_mfma_f32_32x32x16_bf16 v[44:59], v[120:123], v[100:103], v[44:59]
    v_mfma_f32_32x32x16_bf16 v[60:75], v[116:119], v[104:107], v[60:75]
    v_mfma_f32_16x16x32_bf16 v[132:135], v[116:119], v[136:139], v[132:135]
    s_mul_i32 s6, s4, 1280
    s_add_u32 s6, s6, 98304
    v_add_u32 v2, s6, v150
    ds_write_b128 v2, v[140:143]
    s_mov_b64 exec, 0xffff
    ds_write_b128 v2, v[144:147] offset:1024
    s_mov_b64 exec, -1
    s_waitcnt lgkmcnt(3)
    v_mfma_f32_32x32x16_bf16 v[28:43], v[108:111], v[92:95], v[28:43]
    ds_read_b64_tr_b16 v[116:117], v23 offset:16384
    ds_read_b64_tr_b16 v[118:119], v23 offset:17408
    ds_read_b128 v[100:103], v11 offset:0
    s_waitcnt lgkmcnt(3)
    v_mfma_f32_32x32x16_bf16 v[76:91], v[112:115], v[96:99], v[76:91]
    ds_read_b64_tr_b16 v[120:121], v25 offset:16384
    ds_read_b64_tr_b16 v[122:123], v25 offset:17408
    ds_read_b128 v[104:107], v15 offset:0
    v_lshlrev_b32 v128, 16, v92
    v_and_b32 v129, s60, v92
    v_add_f32 v124, v124, v128
    v_add_f32 v125, v125, v129
    v_fmac_f32 v126, v128, v128
    v_fmac_f32 v127, v129, v129
    v_mfma_f32_32x32x16_bf16 v[44:59], v[112:115], v[92:95], v[44:59]
    v_lshlrev_b32 v130, 16, v93
    v_and_b32 v131, s60, v93
    v_add_f32 v124, v124, v130
    v_add_f32 v125, v125, v131
    v_fmac_f32 v126, v130, v130
    v_fmac_f32 v127, v131, v131
    v_mfma_f32_32x32x16_bf16 v[60:75], v[108:111], v[96:99], v[60:75]
    v_lshlrev_b32 v128, 16, v94
    v_and_b32 v129, s60, v94
    v_add_f32 v124, v124, v128
    v_add_f32 v125, v125, v129
    v_fmac_f32 v126, v128, v128
    v_fmac_f32 v127, v129, v129
    v_mfma_f32_16x16x32_bf16 v[132:135], v[108:111], v[136:139], v[132:135]
    v_lshlrev_b32 v130, 16, v95
    v_and_b32 v131, s60, v95
    v_add_f32 v124, v124, v130
    v_add_f32 v125, v125, v131
    v_fmac_f32 v126, v130, v130
    v_fmac_f32 v127, v131, v131
    s_waitcnt vmcnt(6)
    s_barrier
    s_waitcnt lgkmcnt(3)
    v_mfma_f32_32x32x16_bf16 v[28:43], v[116:119], v[100:103], v[28:43]
    ds_read_b64_tr_b16 v[108:109], v22 offset:32768
    ds_read_b64_tr_b16 v[110:111], v22 offset:33792
    ds_read_b128 v[92:95], v12 offset:0
    s_waitcnt lgkmcnt(3)
    v_mfma_f32_32x32x16_bf16 v[76:91], v[120:123], v[104:107], v[76:91]
    ds_read_b64_tr_b16 v[112:113], v24 offset:32768
    ds_read_b64_tr_b16 v[114:115], v24 offset:33792
    ds_read_b128 v[96:99], v16 offset:0
    v_mfma_f32_32x32x16_bf16 v[44:59], v[120:123], v[100:103], v[44:59]
    v_mfma_f32_32x32x16_bf16 v[60:75], v[116:119], v[104:107], v[60:75]
    v_mfma_f32_16x16x32_bf16 v[132:135], v[116:119], v[136:139], v[132:135]
    s_waitcnt lgkmcnt(3)
    v_mfma_f32_32x32x16_bf16 v[28:43], v[108:111], v[92:95], v[28:43]
    ds_read_b64_tr_b16 v[116:117], v23 offset:32768
    ds_read_b64_tr_b16 v[118:119], v23 offset:33792
    ds_read_b128 v[100:103], v13 offset:0
    s_waitcnt lgkmcnt(3)
    v_mfma_f32_32x32x16_bf16 v[76:91], v[112:115], v[96:99], v[76:91]
    ds_read_b64_tr_b16 v[120:121], v25 offset:32768
    ds_read_b64_tr_b16 v[122:123], v25 offset:33792
    ds_read_b128 v[104:107], v17 offset:0
    v_lshlrev_b32 v128, 16, v92
    v_and_b32 v129, s60, v92
    v_add_f32 v124, v124, v128
    v_add_f32 v125, v125, v129
    v_fmac_f32 v126, v128, v128
    v_fmac_f32 v127, v129, v129
    v_mfma_f32_32x32x16_bf16 v[44:59], v[112:115], v[92:95], v[44:59]
    v_lshlrev_b32 v130, 16, v93
    v_and_b32 v131, s60, v93
    v_add_f32 v124, v124, v130
    v_add_f32 v125, v125, v131
    v_fmac_f32 v126, v130, v130
    v_fmac_f32 v127, v131, v131
    v_mfma_f32_32x32x16_bf16 v[60:75], v[108:111], v[96:99], v[60:75]
    v_lshlrev_b32 v128, 16, v94
    v_and_b32 v129, s60, v94
    v_add_f32 v124, v124, v128
    v_add_f32 v125, v125, v129
    v_fmac_f32 v126, v128, v128
    v_fmac_f32 v127, v129, v129
    v_mfma_f32_16x16x32_bf16 v[132:135], v[108:111], v[136:139], v[132:135]
    v_lshlrev_b32 v130, 16, v95
    v_and_b32 v131, s60, v95
    v_add_f32 v124, v124, v130
    v_add_f32 v125, v125, v131
    v_fmac_f32 v126, v130, v130
    v_fmac_f32 v127, v131, v131
    s_waitcnt vmcnt(2)
    s_barrier
    s_waitcnt lgkmcnt(3)
    v_mfma_f32_32x32x16_bf16 v[28:43], v[116:119], v[100:103], v[28:43]
    ds_read_b64_tr_b16 v[108:109], v18 offset:0
    ds_read_b64_tr_b16 v[110:111], v18 offset:1024
    ds_read_b128 v[92:95], v10 offset:16384
    s_waitcnt lgkmcnt(3)
    v_mfma_f32_32x32x16_bf16 v[76:91], v[120:123], v[104:107], v[76:91]
    ds_read_b64_tr_b16 v[112:113], v20 offset:0
    ds_read_b64_tr_b16 v[114:115], v20 offset:1024
    ds_read_b128 v[96:99], v14 offset:16384
    v_mfma_f32_32x32x16_bf16 v[44:59], v[120:123], v[100:103], v[44:59]
    v_mfma_f32_32x32x16_bf16 v[60:75], v[116:119], v[104:107], v[60:75]
    v_mfma_f32_16x16x32_bf16 v[132:135], v[116:119], v[136:139], v[132:135]
    s_waitcnt lgkmcnt(3)
    v_mfma_f32_32x32x16_bf16 v[28:43], v[108:111], v[92:95], v[28:43]
    ds_read_b64_tr_b16 v[116:117], v19 offset:0
    ds_read_b64_tr_b16 v[118:119], v19 offset:1024
    ds_read_b128 v[100:103], v11 offset:16384
    s_waitcnt lgkmcnt(3)
    v_mfma_f32_32x32x16_bf16 v[76:91], v[112:115], v[96:99], v[76:91]
    ds_read_b64_tr_b16 v[120:121], v21 offset:0
    ds_read_b64_tr_b16 v[122:123], v21 offset:1024
    ds_read_b128 v[104:107], v15 offset:16384
    v_lshlrev_b32 v128, 16, v92
    v_and_b32 v129, s60, v92
    v_add_f32 v124, v124, v128
    v_add_f32 v125, v125, v129
    v_fmac_f32 v126, v128, v128
    v_fmac_f32 v127, v129, v129
    v_mfma_f32_32x32x16_bf16 v[44:59], v[112:115], v[92:95], v[44:59]
    v_lshlrev_b32 v130, 16, v93
    v_and_b32 v131, s60, v93
    v_add_f32 v124, v124, v130
    v_add_f32 v125, v125, v131
    v_fmac_f32 v126, v130, v130
    v_fmac_f32 v127, v131, v131
    v_mfma_f32_32x32x16_bf16 v[60:75], v[108:111], v[96:99], v[60:75]
    v_lshlrev_b32 v128, 16, v94
    v_and_b32 v129, s60, v94
    v_add_f32 v124, v124, v128
    v_add_f32 v125, v125, v129
    v_fmac_f32 v126, v128, v128
    v_fmac_f32 v127, v129, v129
    v_mfma_f32_16x16x32_bf16 v[132:135], v[108:111], v[136:139], v[132:135]
    v_lshlrev_b32 v130, 16, v95
    v_and_b32 v131, s60, v95
    v_add_f32 v124, v124, v130
    v_add_f32 v125, v125, v131
    v_fmac_f32 v126, v130, v130
    v_fmac_f32 v127, v131, v131
    s_waitcnt vmcnt(0)
    s_barrier
    s_waitcnt lgkmcnt(3)
    v_mfma_f32_32x32x16_bf16 v[28:43], v[116:119], v[100:103], v[28:43]
    ds_read_b64_tr_b16 v[108:109], v18 offset:16384
    ds_read_b64_tr_b16 v[110:111], v18 offset:17408
    ds_read_b128 v[92:95], v12 offset:16384
    s_waitcnt lgkmcnt(3)
    v_mfma_f32_32x32x16_bf16 v[76:91], v[120:123], v[104:107], v[76:91]
    ds_read_b64_tr_b16 v[112:113], v20 offset:16384
    ds_read_b64_tr_b16 v[114:115], v20 offset:17408
    ds_read_b128 v[96:99], v16 offset:16384
    v_mfma_f32_32x32x16_bf16 v[44:59], v[120:123], v[100:103], v[44:59]
    ds_read_b64_tr_b16 v[140:141], v148 offset:0
    ds_read_b64_tr_b16 v[142:143], v148 offset:2560
    ds_read_b64_tr_b16 v[144:145], v149 offset:0
    ds_read_b64_tr_b16 v[146:147], v149 offset:2560
    v_mfma_f32_32x32x16_bf16 v[60:75], v[116:119], v[104:107], v[60:75]
    v_mfma_f32_16x16x32_bf16 v[132:135], v[116:119], v[136:139], v[132:135]
    s_waitcnt lgkmcnt(3)
    v_mfma_f32_32x32x16_bf16 v[28:43], v[108:111], v[92:95], v[28:43]
    ds_read_b64_tr_b16 v[116:117], v19 offset:16384
    ds_read_b64_tr_b16 v[118:119], v19 offset:17408
    ds_read_b128 v[100:103], v13 offset:16384
    s_waitcnt lgkmcnt(3)
    v_mfma_f32_32x32x16_bf16 v[76:91], v[112:115], v[96:99], v[76:91]
    ds_read_b64_tr_b16 v[120:121], v21 offset:16384
    ds_read_b64_tr_b16 v[122:123], v21 offset:17408
    ds_read_b128 v[104:107], v17 offset:16384
    v_lshlrev_b32 v128, 16, v92
    v_and_b32 v129, s60, v92
    v_add_f32 v124, v124, v128
    v_add_f32 v125, v125, v129
    v_fmac_f32 v126, v128, v128
    v_fmac_f32 v127, v129, v129
    v_mfma_f32_32x32x16_bf16 v[44:59], v[112:115], v[92:95], v[44:59]
    v_lshlrev_b32 v130, 16, v93
    v_and_b32 v131, s60, v93
    v_add_f32 v124, v124, v130
    v_add_f32 v125, v125, v131
    v_fmac_f32 v126, v130, v130
    v_fmac_f32 v127, v131, v131
    buffer_store_dwordx4 v[140:143], v150, s[68:71], s62 offen sc1
    s_cmp_lt_u32 s4, 2
    s_cselect_b32 s63, s63, 0x7fffffff
    buffer_store_dwordx4 v[144:147], v150, s[68:71], s63 offen sc1
    v_mfma_f32_32x32x16_bf16 v[60:75], v[108:111], v[96:99], v[60:75]
    v_lshlrev_b32 v128, 16, v94
    v_and_b32 v129, s60, v94
    v_add_f32 v124, v124, v128
    v_add_f32 v125, v125, v129
    v_fmac_f32 v126, v128, v128
    v_fmac_f32 v127, v129, v129
    v_mfma_f32_16x16x32_bf16 v[132:135], v[108:111], v[136:139], v[132:135]
    v_lshlrev_b32 v130, 16, v95
    v_and_b32 v131, s60, v95
    v_add_f32 v124, v124, v130
    v_add_f32 v125, v125, v131
    v_fmac_f32 v126, v130, v130
    v_fmac_f32 v127, v131, v131
    s_waitcnt lgkmcnt(3)
    v_mfma_f32_32x32x16_bf16 v[28:43], v[116:119], v[100:103], v[28:43]
    v_mfma_f32_16x16x32_bf16 v[132:135], v[116:119], v[136:139], v[132:135]
    v_add_f32 v124, v124, v125
    v_add_f32 v125, v126, v127
    v_mov_b32 v2, v124
    v_mov_b32 v3, v125
    s_waitcnt lgkmcnt(0)
    v_mfma_f32_32x32x16_bf16 v[76:91], v[120:123], v[104:107], v[76:91]
    v_permlane32_swap_b32 v124, v2
    v_permlane32_swap_b32 v125, v3
    v_add_f32 v124, v124, v2
    v_add_f32 v125, v125, v3
    v_mfma_f32_32x32x16_bf16 v[44:59], v[120:123], v[100:103], v[44:59]
    ds_write_b64 v151, v[124:125]
    ds_write_b128 v154, v[132:135]
    v_mfma_f32_32x32x16_bf16 v[60:75], v[116:119], v[104:107], v[60:75]
    s_waitcnt lgkmcnt(0)
    s_barrier
    ds_read_b64 v[158:159], v152
    ds_read_b64 v[160:161], v152 offset:256
    ds_read_b64 v[162:163], v153
    ds_read_b64 v[164:165], v153 offset:256
    ds_read_b128 v[168:171], v155 offset:0
    ds_read_b128 v[172:175], v155 offset:32
    ds_read_b128 v[176:179], v155 offset:64
    ds_read_b128 v[180:183], v155 offset:96
    ds_read_b128 v[184:187], v156 offset:0
    ds_read_b128 v[188:191], v156 offset:32
    ds_read_b128 v[192:195], v156 offset:64
    ds_read_b128 v[196:199], v156 offset:96
    s_waitcnt lgkmcnt(8)
    v_pk_add_f32 v[158:159], v[158:159], v[160:161]
    v_mul_f32 v158, 0x3acccccd, v158
    v_mul_f32 v159, 0x3acccccd, v159
    v_fma_f32 v159, -v158, v158, v159
    v_max_f32 v159, 0, v159
    v_cvt_pk_bf16_f32 v200, v158, v158
    v_and_b32 v200, 0xffff0000, v200
    v_cvt_pk_bf16_f32 v2, v159, v159
    v_and_b32 v2, 0xffff0000, v2
    v_add_f32 v2, 0x3727c5ac, v2
    v_cvt_pk_bf16_f32 v2, v2, v2
    v_and_b32 v2, 0xffff0000, v2
    v_sqrt_f32 v2, v2
    s_nop 0
    v_cvt_pk_bf16_f32 v2, v2, v2
    v_and_b32 v2, 0xffff0000, v2
    v_rcp_f32 v201, v2
    s_nop 0
    v_mul_f32 v201, v201, v201
    v_pk_add_f32 v[162:163], v[162:163], v[164:165]
    v_mul_f32 v162, 0x3acccccd, v162
    v_mul_f32 v163, 0x3acccccd, v163
    v_fma_f32 v163, -v162, v162, v163
    v_max_f32 v163, 0, v163
    v_cvt_pk_bf16_f32 v202, v162, v162
    v_and_b32 v202, 0xffff0000, v202
    v_cvt_pk_bf16_f32 v2, v163, v163
    v_and_b32 v2, 0xffff0000, v2
    v_add_f32 v2, 0x3727c5ac, v2
    v_cvt_pk_bf16_f32 v2, v2, v2
    v_and_b32 v2, 0xffff0000, v2
    v_sqrt_f32 v2, v2
    s_nop 0
    v_cvt_pk_bf16_f32 v2, v2, v2
    v_and_b32 v2, 0xffff0000, v2
    v_rcp_f32 v203, v2
    s_nop 0
    v_mul_f32 v203, v203, v203
    s_waitcnt lgkmcnt(0)
    v_pk_fma_f32 v[28:29], v[168:169], v[200:201], v[28:29] op_sel_hi:[1,0,1] neg_lo:[0,1,0] neg_hi:[0,1,0]
    v_pk_fma_f32 v[44:45], v[184:185], v[200:201], v[44:45] op_sel_hi:[1,0,1] neg_lo:[0,1,0] neg_hi:[0,1,0]
    v_pk_mul_f32 v[28:29], v[28:29], v[44:45]
    v_pk_mul_f32 v[28:29], v[28:29], v[200:201] op_sel:[0,1] op_sel_hi:[1,1]
    v_pk_fma_f32 v[30:31], v[170:171], v[200:201], v[30:31] op_sel_hi:[1,0,1] neg_lo:[0,1,0] neg_hi:[0,1,0]
    v_pk_fma_f32 v[46:47], v[186:187], v[200:201], v[46:47] op_sel_hi:[1,0,1] neg_lo:[0,1,0] neg_hi:[0,1,0]
    v_pk_mul_f32 v[30:31], v[30:31], v[46:47]
    v_pk_mul_f32 v[30:31], v[30:31], v[200:201] op_sel:[0,1] op_sel_hi:[1,1]
    v_pk_fma_f32 v[32:33], v[172:173], v[200:201], v[32:33] op_sel_hi:[1,0,1] neg_lo:[0,1,0] neg_hi:[0,1,0]
    v_pk_fma_f32 v[48:49], v[188:189], v[200:201], v[48:49] op_sel_hi:[1,0,1] neg_lo:[0,1,0] neg_hi:[0,1,0]
    v_pk_mul_f32 v[32:33], v[32:33], v[48:49]
    v_pk_mul_f32 v[32:33], v[32:33], v[200:201] op_sel:[0,1] op_sel_hi:[1,1]
    v_pk_fma_f32 v[34:35], v[174:175], v[200:201], v[34:35] op_sel_hi:[1,0,1] neg_lo:[0,1,0] neg_hi:[0,1,0]
    v_pk_fma_f32 v[50:51], v[190:191], v[200:201], v[50:51] op_sel_hi:[1,0,1] neg_lo:[0,1,0] neg_hi:[0,1,0]
    v_pk_mul_f32 v[34:35], v[34:35], v[50:51]
    v_pk_mul_f32 v[34:35], v[34:35], v[200:201] op_sel:[0,1] op_sel_hi:[1,1]
    v_pk_fma_f32 v[36:37], v[176:177], v[200:201], v[36:37] op_sel_hi:[1,0,1] neg_lo:[0,1,0] neg_hi:[0,1,0]
    v_pk_fma_f32 v[52:53], v[192:193], v[200:201], v[52:53] op_sel_hi:[1,0,1] neg_lo:[0,1,0] neg_hi:[0,1,0]
    v_pk_mul_f32 v[36:37], v[36:37], v[52:53]
    v_pk_mul_f32 v[36:37], v[36:37], v[200:201] op_sel:[0,1] op_sel_hi:[1,1]
    v_pk_fma_f32 v[38:39], v[178:179], v[200:201], v[38:39] op_sel_hi:[1,0,1] neg_lo:[0,1,0] neg_hi:[0,1,0]
    v_pk_fma_f32 v[54:55], v[194:195], v[200:201], v[54:55] op_sel_hi:[1,0,1] neg_lo:[0,1,0] neg_hi:[0,1,0]
    v_pk_mul_f32 v[38:39], v[38:39], v[54:55]
    v_pk_mul_f32 v[38:39], v[38:39], v[200:201] op_sel:[0,1] op_sel_hi:[1,1]
    v_pk_fma_f32 v[40:41], v[180:181], v[200:201], v[40:41] op_sel_hi:[1,0,1] neg_lo:[0,1,0] neg_hi:[0,1,0]
    v_pk_fma_f32 v[56:57], v[196:197], v[200:201], v[56:57] op_sel_hi:[1,0,1] neg_lo:[0,1,0] neg_hi:[0,1,0]
    v_pk_mul_f32 v[40:41], v[40:41], v[56:57]
    v_pk_mul_f32 v[40:41], v[40:41], v[200:201] op_sel:[0,1] op_sel_hi:[1,1]
    v_pk_fma_f32 v[42:43], v[182:183], v[200:201], v[42:43] op_sel_hi:[1,0,1] neg_lo:[0,1,0] neg_hi:[0,1,0]
    v_pk_fma_f32 v[58:59], v[198:199], v[200:201], v[58:59] op_sel_hi:[1,0,1] neg_lo:[0,1,0] neg_hi:[0,1,0]
    v_pk_mul_f32 v[42:43], v[42:43], v[58:59]
    v_pk_mul_f32 v[42:43], v[42:43], v[200:201] op_sel:[0,1] op_sel_hi:[1,1]
    v_cvt_pk_bf16_f32 v44, v28, v29
    v_cvt_pk_bf16_f32 v45, v30, v31
    v_cvt_pk_bf16_f32 v46, v32, v33
    v_cvt_pk_bf16_f32 v47, v34, v35
    v_cvt_pk_bf16_f32 v48, v36, v37
    v_cvt_pk_bf16_f32 v49, v38, v39
    v_cvt_pk_bf16_f32 v50, v40, v41
    v_cvt_pk_bf16_f32 v51, v42, v43
    buffer_store_dwordx4 v[44:47], v157, s[48:51], s9 offen offset:0 sc1
    buffer_store_dwordx4 v[48:51], v157, s[48:51], s9 offen offset:512 sc1
    v_pk_fma_f32 v[60:61], v[168:169], v[202:203], v[60:61] op_sel_hi:[1,0,1] neg_lo:[0,1,0] neg_hi:[0,1,0]
    v_pk_fma_f32 v[76:77], v[184:185], v[202:203], v[76:77] op_sel_hi:[1,0,1] neg_lo:[0,1,0] neg_hi:[0,1,0]
    v_pk_mul_f32 v[60:61], v[60:61], v[76:77]
    v_pk_mul_f32 v[60:61], v[60:61], v[202:203] op_sel:[0,1] op_sel_hi:[1,1]
    v_pk_fma_f32 v[62:63], v[170:171], v[202:203], v[62:63] op_sel_hi:[1,0,1] neg_lo:[0,1,0] neg_hi:[0,1,0]
    v_pk_fma_f32 v[78:79], v[186:187], v[202:203], v[78:79] op_sel_hi:[1,0,1] neg_lo:[0,1,0] neg_hi:[0,1,0]
    v_pk_mul_f32 v[62:63], v[62:63], v[78:79]
    v_pk_mul_f32 v[62:63], v[62:63], v[202:203] op_sel:[0,1] op_sel_hi:[1,1]
    v_pk_fma_f32 v[64:65], v[172:173], v[202:203], v[64:65] op_sel_hi:[1,0,1] neg_lo:[0,1,0] neg_hi:[0,1,0]
    v_pk_fma_f32 v[80:81], v[188:189], v[202:203], v[80:81] op_sel_hi:[1,0,1] neg_lo:[0,1,0] neg_hi:[0,1,0]
    v_pk_mul_f32 v[64:65], v[64:65], v[80:81]
    v_pk_mul_f32 v[64:65], v[64:65], v[202:203] op_sel:[0,1] op_sel_hi:[1,1]
    v_pk_fma_f32 v[66:67], v[174:175], v[202:203], v[66:67] op_sel_hi:[1,0,1] neg_lo:[0,1,0] neg_hi:[0,1,0]
    v_pk_fma_f32 v[82:83], v[190:191], v[202:203], v[82:83] op_sel_hi:[1,0,1] neg_lo:[0,1,0] neg_hi:[0,1,0]
    v_pk_mul_f32 v[66:67], v[66:67], v[82:83]
    v_pk_mul_f32 v[66:67], v[66:67], v[202:203] op_sel:[0,1] op_sel_hi:[1,1]
    v_pk_fma_f32 v[68:69], v[176:177], v[202:203], v[68:69] op_sel_hi:[1,0,1] neg_lo:[0,1,0] neg_hi:[0,1,0]
    v_pk_fma_f32 v[84:85], v[192:193], v[202:203], v[84:85] op_sel_hi:[1,0,1] neg_lo:[0,1,0] neg_hi:[0,1,0]
    v_pk_mul_f32 v[68:69], v[68:69], v[84:85]
    v_pk_mul_f32 v[68:69], v[68:69], v[202:203] op_sel:[0,1] op_sel_hi:[1,1]
    v_pk_fma_f32 v[70:71], v[178:179], v[202:203], v[70:71] op_sel_hi:[1,0,1] neg_lo:[0,1,0] neg_hi:[0,1,0]
    v_pk_fma_f32 v[86:87], v[194:195], v[202:203], v[86:87] op_sel_hi:[1,0,1] neg_lo:[0,1,0] neg_hi:[0,1,0]
    v_pk_mul_f32 v[70:71], v[70:71], v[86:87]
    v_pk_mul_f32 v[70:71], v[70:71], v[202:203] op_sel:[0,1] op_sel_hi:[1,1]
    v_pk_fma_f32 v[72:73], v[180:181], v[202:203], v[72:73] op_sel_hi:[1,0,1] neg_lo:[0,1,0] neg_hi:[0,1,0]
    v_pk_fma_f32 v[88:89], v[196:197], v[202:203], v[88:89] op_sel_hi:[1,0,1] neg_lo:[0,1,0] neg_hi:[0,1,0]
    v_pk_mul_f32 v[72:73], v[72:73], v[88:89]
    v_pk_mul_f32 v[72:73], v[72:73], v[202:203] op_sel:[0,1] op_sel_hi:[1,1]
    v_pk_fma_f32 v[74:75], v[182:183], v[202:203], v[74:75] op_sel_hi:[1,0,1] neg_lo:[0,1,0] neg_hi:[0,1,0]
    v_pk_fma_f32 v[90:91], v[198:199], v[202:203], v[90:91] op_sel_hi:[1,0,1] neg_lo:[0,1,0] neg_hi:[0,1,0]
    v_pk_mul_f32 v[74:75], v[74:75], v[90:91]
    v_pk_mul_f32 v[74:75], v[74:75], v[202:203] op_sel:[0,1] op_sel_hi:[1,1]
    v_cvt_pk_bf16_f32 v76, v60, v61
    v_cvt_pk_bf16_f32 v77, v62, v63
    v_cvt_pk_bf16_f32 v78, v64, v65
    v_cvt_pk_bf16_f32 v79, v66, v67
    v_cvt_pk_bf16_f32 v80, v68, v69
    v_cvt_pk_bf16_f32 v81, v70, v71
    v_cvt_pk_bf16_f32 v82, v72, v73
    v_cvt_pk_bf16_f32 v83, v74, v75
    buffer_store_dwordx4 v[76:79], v157, s[48:51], s10 offen offset:0 sc1
    buffer_store_dwordx4 v[80:83], v157, s[48:51], s10 offen offset:512 sc1
    s_endpgm
K1_A:
    s_cmp_eq_u32 s4, 7
    s_cbranch_scc0 K1_NOCPFA
    s_getpc_b64 s[6:7]
K1_PCA:
    s_sub_u32 s6, s6, K1_PCA - k1_kernel
    s_subb_u32 s7, s7, 0
    s_lshr_b32 s5, s2, 3
    s_lshl_b32 s5, s5, 11
    v_and_b32 v1, 15, v0
    v_lshl_add_u32 v1, v1, 7, s5
    v_min_u32 v1, CODE_END - k1_kernel - 4, v1
    s_mov_b64 exec, 0xffff
    global_load_dword v255, v1, s[6:7]
    s_mov_b64 exec, -1
K1_NOCPFA:
    s_waitcnt lgkmcnt(0)
    s_mov_b32 s36, s16
    s_mov_b32 s37, s17
    s_mov_b32 s38, 2621440
    s_mov_b32 s39, 0x00020000
    s_add_u32 s40, s34, 8388608
    s_addc_u32 s41, s35, 0
    s_mov_b32 s42, 2686976
    s_mov_b32 s43, 0x00020000
    s_and_b32 s5, s2, 7
    s_lshr_b32 s6, s2, 3
    s_lshl_b32 s5, s5, 3
    s_add_u32 s52, s5, s6
    s_lshr_b32 s53, s4, 2
    v_and_b32 v1, 63, v0
    v_and_b32 v5, 15, v0
    v_lshrrev_b32 v8, 4, v0
    s_mul_i32 s13, s4, 5440
    s_lshl_b32 s5, s4, 8
    s_add_u32 s5, s5, s52
    s_mul_i32 s5, s5, 1280
    s_mov_b32 s6, 820
    v_add_u32 v2, 0, v1
    v_mul_u32_u24 v3, s6, v2
    v_lshrrev_b32 v3, 16, v3
    v_mul_u32_u24 v3, 80640, v3
    v_lshl_add_u32 v3, v2, 4, v3
    s_add_u32 m0, s13, 0
    s_nop 0
    buffer_load_dwordx4 v3, s[36:39], s5 offen lds
    v_add_u32 v2, 64, v1
    v_mul_u32_u24 v3, s6, v2
    v_lshrrev_b32 v3, 16, v3
    v_mul_u32_u24 v3, 80640, v3
    v_lshl_add_u32 v3, v2, 4, v3
    s_add_u32 m0, s13, 1024
    s_nop 0
    buffer_load_dwordx4 v3, s[36:39], s5 offen lds
    v_add_u32 v2, 128, v1
    v_mul_u32_u24 v3, s6, v2
    v_lshrrev_b32 v3, 16, v3
    v_mul_u32_u24 v3, 80640, v3
    v_lshl_add_u32 v3, v2, 4, v3
    s_add_u32 m0, s13, 2048
    s_nop 0
    buffer_load_dwordx4 v3, s[36:39], s5 offen lds
    v_add_u32 v2, 192, v1
    v_mul_u32_u24 v3, s6, v2
    v_lshrrev_b32 v3, 16, v3
    v_mul_u32_u24 v3, 80640, v3
    v_lshl_add_u32 v3, v2, 4, v3
    s_add_u32 m0, s13, 3072
    s_nop 0
    buffer_load_dwordx4 v3, s[36:39], s5 offen lds
    v_add_u32 v2, 256, v1
    v_mul_u32_u24 v3, s6, v2
    v_lshrrev_b32 v3, 16, v3
    v_mul_u32_u24 v3, 80640, v3
    v_lshl_add_u32 v3, v2, 4, v3
    s_add_u32 m0, s13, 4096
    s_nop 0
    buffer_load_dwordx4 v3, s[36:39], s5 offen lds
    v_lshrrev_b32 v7, 4, v1
    v_mov_b32 v6, v5
    s_lshl_b32 s5, s4, 2
    s_mov_b32 s6, 0x74208630
    s_lshr_b32 s6, s6, s5
    s_and_b32 s54, s6, 15
    s_lshr_b32 s6, 0xC3, s4
    s_and_b32 s55, s6, 1
    s_lshl_b32 s5, s4, 9
    s_and_b32 s5, s5, 0x400
    s_and_b32 s6, s4, 1
    s_lshl_b32 s7, s6, 7
    s_add_u32 s5, s5, s7
    s_add_u32 s5, s5, s52
    v_lshl_add_u32 v2, v7, 8, s5
    v_cvt_f32_u32 v2, v2
    s_lshl_b32 s5, s53, 4
    v_add_u32 v3, s5, v6
    v_cvt_f32_u32 v3, v3
    v_mul_f32 v207, 0x3a000000, v3
    v_mul_f32 v204, v207, v2
    v_fmamk_f32 v205, v207, 0x42800000, v204
    v_cos_f32 v160, v204
    v_sin_f32 v161, v204
    v_cos_f32 v162, v205
    v_sin_f32 v163, v205
    s_lshr_b32 s5, s4, 1
    s_lshl_b32 s5, s5, 11
    s_lshl_b32 s6, s6, 3
    s_add_u32 s5, s5, s6
    s_add_u32 s5, s5, 151552
    v_lshl_add_u32 v206, v1, 4, s5
    v_cvt_pk_bf16_f32 v180, v160, -v161
    v_cvt_pk_bf16_f32 v181, v162, -v163
    v_cvt_pk_bf16_f32 v182, -v161, -v160
    v_cvt_pk_bf16_f32 v183, -v163, -v162
    ds_write_b64 v206, v[180:181]
    ds_write_b64 v206, v[182:183] offset:1024
    s_waitcnt lgkmcnt(0)
    s_and_b32 s6, s4, 1
    s_lshl_b32 s5, s6, 4
    s_bfe_u32 s7, s4, 0x10001
    s_add_u32 s5, s5, s7
    v_lshl_add_u32 v2, v7, 2, s5
    v_cvt_f32_u32 v2, v2
    v_mul_f32 v207, 0x3c800000, v3
    v_mul_f32 v204, v207, v2
    v_fmamk_f32 v205, v207, 0x40000000, v204
    v_cos_f32 v160, v204
    v_sin_f32 v161, v204
    v_cos_f32 v162, v205
    v_sin_f32 v163, v205
    v_add_u32 v206, -40960, v206
    v_cvt_pk_bf16_f32 v180, v160, v161
    v_cvt_pk_bf16_f32 v181, v162, v163
    v_cvt_pk_bf16_f32 v182, -v161, v160
    v_cvt_pk_bf16_f32 v183, -v163, v162
    ds_write_b64 v206, v[180:181]
    ds_write_b64 v206, v[182:183] offset:1024
    s_waitcnt lgkmcnt(0)
    v_mul_u32_u24 v203, 10, v7
    v_cvt_f32_u32 v203, v203
    s_mov_b32 s44, s18
    s_mov_b32 s45, s19
    s_mov_b32 s46, 1314816
    s_mov_b32 s47, 0x00020000
    s_mov_b32 s48, s20
    s_mov_b32 s49, s21
    s_mov_b32 s50, 1314816
    s_mov_b32 s51, 0x00020000
    s_and_b32 s8, s2, 7
    s_lshl_b32 s8, s8, 2
    s_lshl_b32 s9, s4, 8
    s_add_u32 s8, s8, s9
    s_lshr_b32 s9, s2, 3
    s_mul_i32 s9, s9, 80
    v_bfe_u32 v36, v1, 3, 2
    v_lshrrev_b32 v37, 5, v1
    v_lshl_add_u32 v36, v37, 5, v36
    v_add_u32 v36, s8, v36
    v_mul_u32_u24 v36, 642, v36
    v_add_u32 v36, s9, v36
    v_and_b32 v36, -16, v36
    v_lshrrev_b32 v37, 3, v1
    v_xor_b32 v37, v37, v1
    v_and_b32 v37, 7, v37
    v_lshl_add_u32 v36, v37, 4, v36
    v_cmp_gt_u32 vcc, 6, v37
    v_mov_b32 v37, 0x7fffffff
    s_nop 0
    v_cndmask_b32 v36, v37, v36, vcc
    s_lshl_b32 s8, s4, 12
    s_add_u32 s5, s54, 0
    s_lshl_b32 s5, s5, 5
    s_add_u32 s5, s5, s53
    v_lshl_add_u32 v202, v6, 1, s5
    v_cvt_f32_u32 v202, v202
    v_mul_f32 v202, 0x3acccccd, v202
    v_cos_f32 v200, v202
    v_mul_f32 v204, 0x42200000, v202
    v_cos_f32 v201, v204
    s_nop 0
    v_pk_add_f32 v[200:201], v[200:201], v[200:201]
    v_add_f32 v204, 0x00000000, v203
    v_mul_f32 v204, v204, v202
    v_cos_f32 v160, v204
    v_sin_f32 v161, v204
    v_add_f32 v205, 0x3f800000, v203
    v_mul_f32 v205, v205, v202
    v_cos_f32 v162, v205
    v_sin_f32 v163, v205
    v_add_f32 v204, 0x42200000, v203
    v_mul_f32 v204, v204, v202
    v_cos_f32 v180, v204
    v_sin_f32 v181, v204
    v_add_f32 v205, 0x42240000, v203
    v_mul_f32 v205, v205, v202
    v_cos_f32 v182, v205
    v_sin_f32 v183, v205
    v_pk_fma_f32 v[164:165], v[162:163], v[200:201], v[160:161] op_sel_hi:[1,0,1] neg_lo:[0,0,1] neg_hi:[0,0,1]
    v_pk_fma_f32 v[184:185], v[182:183], v[200:201], v[180:181] op_sel_hi:[1,0,1] neg_lo:[0,0,1] neg_hi:[0,0,1]
    v_pk_fma_f32 v[166:167], v[164:165], v[200:201], v[162:163] op_sel_hi:[1,0,1] neg_lo:[0,0,1] neg_hi:[0,0,1]
    v_pk_fma_f32 v[186:187], v[184:185], v[200:201], v[182:183] op_sel_hi:[1,0,1] neg_lo:[0,0,1] neg_hi:[0,0,1]
    v_pk_fma_f32 v[168:169], v[166:167], v[200:201], v[164:165] op_sel_hi:[1,0,1] neg_lo:[0,0,1] neg_hi:[0,0,1]
    v_pk_fma_f32 v[188:189], v[186:187], v[200:201], v[184:185] op_sel_hi:[1,0,1] neg_lo:[0,0,1] neg_hi:[0,0,1]
    v_pk_fma_f32 v[170:171], v[168:169], v[200:201], v[166:167] op_sel_hi:[1,0,1] neg_lo:[0,0,1] neg_hi:[0,0,1]
    v_pk_fma_f32 v[190:191], v[188:189], v[200:201], v[186:187] op_sel_hi:[1,0,1] neg_lo:[0,0,1] neg_hi:[0,0,1]
    v_pk_fma_f32 v[172:173], v[170:171], v[200:201], v[168:169] op_sel_hi:[1,0,1] neg_lo:[0,0,1] neg_hi:[0,0,1]
    v_pk_fma_f32 v[192:193], v[190:191], v[200:201], v[188:189] op_sel_hi:[1,0,1] neg_lo:[0,0,1] neg_hi:[0,0,1]
    v_pk_fma_f32 v[174:175], v[172:173], v[200:201], v[170:171] op_sel_hi:[1,0,1] neg_lo:[0,0,1] neg_hi:[0,0,1]
    v_pk_fma_f32 v[194:195], v[192:193], v[200:201], v[190:191] op_sel_hi:[1,0,1] neg_lo:[0,0,1] neg_hi:[0,0,1]
    v_pk_fma_f32 v[176:177], v[174:175], v[200:201], v[172:173] op_sel_hi:[1,0,1] neg_lo:[0,0,1] neg_hi:[0,0,1]
    v_pk_fma_f32 v[196:197], v[194:195], v[200:201], v[192:193] op_sel_hi:[1,0,1] neg_lo:[0,0,1] neg_hi:[0,0,1]
    v_pk_fma_f32 v[178:179], v[176:177], v[200:201], v[174:175] op_sel_hi:[1,0,1] neg_lo:[0,0,1] neg_hi:[0,0,1]
    v_pk_fma_f32 v[198:199], v[196:197], v[200:201], v[194:195] op_sel_hi:[1,0,1] neg_lo:[0,0,1] neg_hi:[0,0,1]
    v_cvt_pk_bf16_f32 v40, v160, v162
    v_cvt_pk_bf16_f32 v100, v161, v163
    v_cvt_pk_bf16_f32 v41, v164, v166
    v_cvt_pk_bf16_f32 v101, v165, v167
    v_cvt_pk_bf16_f32 v42, v168, v170
    v_cvt_pk_bf16_f32 v102, v169, v171
    v_cvt_pk_bf16_f32 v43, v172, v174
    v_cvt_pk_bf16_f32 v103, v173, v175
    v_cvt_pk_bf16_f32 v56, v176, v178
    v_cvt_pk_bf16_f32 v116, v177, v179
    v_cvt_pk_bf16_f32 v44, v180, v182
    v_cvt_pk_bf16_f32 v104, v181, v183
    v_cvt_pk_bf16_f32 v45, v184, v186
    v_cvt_pk_bf16_f32 v105, v185, v187
    v_cvt_pk_bf16_f32 v46, v188, v190
    v_cvt_pk_bf16_f32 v106, v189, v191
    v_cvt_pk_bf16_f32 v47, v192, v194
    v_cvt_pk_bf16_f32 v107, v193, v195
    v_cvt_pk_bf16_f32 v57, v196, v198
    v_cvt_pk_bf16_f32 v117, v197, v199
    v_pk_fma_f32 v[160:161], v[180:181], v[200:201], v[160:161] op_sel:[0,1,0] op_sel_hi:[1,1,1] neg_lo:[0,0,1] neg_hi:[0,0,1]
    v_pk_fma_f32 v[162:163], v[182:183], v[200:201], v[162:163] op_sel:[0,1,0] op_sel_hi:[1,1,1] neg_lo:[0,0,1] neg_hi:[0,0,1]
    v_pk_fma_f32 v[164:165], v[184:185], v[200:201], v[164:165] op_sel:[0,1,0] op_sel_hi:[1,1,1] neg_lo:[0,0,1] neg_hi:[0,0,1]
    v_pk_fma_f32 v[166:167], v[186:187], v[200:201], v[166:167] op_sel:[0,1,0] op_sel_hi:[1,1,1] neg_lo:[0,0,1] neg_hi:[0,0,1]
    v_pk_fma_f32 v[168:169], v[188:189], v[200:201], v[168:169] op_sel:[0,1,0] op_sel_hi:[1,1,1] neg_lo:[0,0,1] neg_hi:[0,0,1]
    v_pk_fma_f32 v[170:171], v[190:191], v[200:201], v[170:171] op_sel:[0,1,0] op_sel_hi:[1,1,1] neg_lo:[0,0,1] neg_hi:[0,0,1]
    v_pk_fma_f32 v[172:173], v[192:193], v[200:201], v[172:173] op_sel:[0,1,0] op_sel_hi:[1,1,1] neg_lo:[0,0,1] neg_hi:[0,0,1]
    v_pk_fma_f32 v[174:175], v[194:195], v[200:201], v[174:175] op_sel:[0,1,0] op_sel_hi:[1,1,1] neg_lo:[0,0,1] neg_hi:[0,0,1]
    v_pk_fma_f32 v[176:177], v[196:197], v[200:201], v[176:177] op_sel:[0,1,0] op_sel_hi:[1,1,1] neg_lo:[0,0,1] neg_hi:[0,0,1]
    v_pk_fma_f32 v[178:179], v[198:199], v[200:201], v[178:179] op_sel:[0,1,0] op_sel_hi:[1,1,1] neg_lo:[0,0,1] neg_hi:[0,0,1]
    v_cvt_pk_bf16_f32 v48, v160, v162
    v_cvt_pk_bf16_f32 v108, v161, v163
    v_cvt_pk_bf16_f32 v49, v164, v166
    v_cvt_pk_bf16_f32 v109, v165, v167
    v_cvt_pk_bf16_f32 v50, v168, v170
    v_cvt_pk_bf16_f32 v110, v169, v171
    v_cvt_pk_bf16_f32 v51, v172, v174
    v_cvt_pk_bf16_f32 v111, v173, v175
    v_cvt_pk_bf16_f32 v58, v176, v178
    v_cvt_pk_bf16_f32 v118, v177, v179
    v_pk_fma_f32 v[180:181], v[160:161], v[200:201], v[180:181] op_sel:[0,1,0] op_sel_hi:[1,1,1] neg_lo:[0,0,1] neg_hi:[0,0,1]
    v_pk_fma_f32 v[182:183], v[162:163], v[200:201], v[182:183] op_sel:[0,1,0] op_sel_hi:[1,1,1] neg_lo:[0,0,1] neg_hi:[0,0,1]
    v_pk_fma_f32 v[184:185], v[164:165], v[200:201], v[184:185] op_sel:[0,1,0] op_sel_hi:[1,1,1] neg_lo:[0,0,1] neg_hi:[0,0,1]
    v_pk_fma_f32 v[186:187], v[166:167], v[200:201], v[186:187] op_sel:[0,1,0] op_sel_hi:[1,1,1] neg_lo:[0,0,1] neg_hi:[0,0,1]
    v_pk_fma_f32 v[188:189], v[168:169], v[200:201], v[188:189] op_sel:[0,1,0] op_sel_hi:[1,1,1] neg_lo:[0,0,1] neg_hi:[0,0,1]
    v_pk_fma_f32 v[190:191], v[170:171], v[200:201], v[190:191] op_sel:[0,1,0] op_sel_hi:[1,1,1] neg_lo:[0,0,1] neg_hi:[0,0,1]
    v_pk_fma_f32 v[192:193], v[172:173], v[200:201], v[192:193] op_sel:[0,1,0] op_sel_hi:[1,1,1] neg_lo:[0,0,1] neg_hi:[0,0,1]
    v_pk_fma_f32 v[194:195], v[174:175], v[200:201], v[194:195] op_sel:[0,1,0] op_sel_hi:[1,1,1] neg_lo:[0,0,1] neg_hi:[0,0,1]
    v_pk_fma_f32 v[196:197], v[176:177], v[200:201], v[196:197] op_sel:[0,1,0] op_sel_hi:[1,1,1] neg_lo:[0,0,1] neg_hi:[0,0,1]
    v_pk_fma_f32 v[198:199], v[178:179], v[200:201], v[198:199] op_sel:[0,1,0] op_sel_hi:[1,1,1] neg_lo:[0,0,1] neg_hi:[0,0,1]
    v_cvt_pk_bf16_f32 v52, v180, v182
    v_cvt_pk_bf16_f32 v112, v181, v183
    v_cvt_pk_bf16_f32 v53, v184, v186
    v_cvt_pk_bf16_f32 v113, v185, v187
    v_cvt_pk_bf16_f32 v54, v188, v190
    v_cvt_pk_bf16_f32 v114, v189, v191
    v_cvt_pk_bf16_f32 v55, v192, v194
    v_cvt_pk_bf16_f32 v115, v193, v195
    v_cvt_pk_bf16_f32 v59, v196, v198
    v_cvt_pk_bf16_f32 v119, v197, v199
    s_mov_b32 s9, 0
    s_add_u32 m0, s8, 45056
    s_nop 0
    buffer_load_dwordx4 v36, s[44:47], s9 offen lds
    s_add_u32 m0, s8, 77824
    s_nop 0
    buffer_load_dwordx4 v36, s[48:51], s9 offen lds
    s_add_u32 s5, s54, 1
    s_lshl_b32 s5, s5, 5
    s_add_u32 s5, s5, s53
    v_lshl_add_u32 v202, v6, 1, s5
    v_cvt_f32_u32 v202, v202
    v_mul_f32 v202, 0x3acccccd, v202
    v_cos_f32 v200, v202
    v_mul_f32 v204, 0x42200000, v202
    v_cos_f32 v201, v204
    s_nop 0
    v_pk_add_f32 v[200:201], v[200:201], v[200:201]
    v_add_f32 v204, 0x00000000, v203
    v_mul_f32 v204, v204, v202
    v_cos_f32 v160, v204
    v_sin_f32 v161, v204
    v_add_f32 v205, 0x3f800000, v203
    v_mul_f32 v205, v205, v202
    v_cos_f32 v162, v205
    v_sin_f32 v163, v205
    v_add_f32 v204, 0x42200000, v203
    v_mul_f32 v204, v204, v202
    v_cos_f32 v180, v204
    v_sin_f32 v181, v204
    v_add_f32 v205, 0x42240000, v203
    v_mul_f32 v205, v205, v202
    v_cos_f32 v182, v205
    v_sin_f32 v183, v205
    v_pk_fma_f32 v[164:165], v[162:163], v[200:201], v[160:161] op_sel_hi:[1,0,1] neg_lo:[0,0,1] neg_hi:[0,0,1]
    v_pk_fma_f32 v[184:185], v[182:183], v[200:201], v[180:181] op_sel_hi:[1,0,1] neg_lo:[0,0,1] neg_hi:[0,0,1]
    v_pk_fma_f32 v[166:167], v[164:165], v[200:201], v[162:163] op_sel_hi:[1,0,1] neg_lo:[0,0,1] neg_hi:[0,0,1]
    v_pk_fma_f32 v[186:187], v[184:185], v[200:201], v[182:183] op_sel_hi:[1,0,1] neg_lo:[0,0,1] neg_hi:[0,0,1]
    v_pk_fma_f32 v[168:169], v[166:167], v[200:201], v[164:165] op_sel_hi:[1,0,1] neg_lo:[0,0,1] neg_hi:[0,0,1]
    v_pk_fma_f32 v[188:189], v[186:187], v[200:201], v[184:185] op_sel_hi:[1,0,1] neg_lo:[0,0,1] neg_hi:[0,0,1]
    v_pk_fma_f32 v[170:171], v[168:169], v[200:201], v[166:167] op_sel_hi:[1,0,1] neg_lo:[0,0,1] neg_hi:[0,0,1]
    v_pk_fma_f32 v[190:191], v[188:189], v[200:201], v[186:187] op_sel_hi:[1,0,1] neg_lo:[0,0,1] neg_hi:[0,0,1]
    v_pk_fma_f32 v[172:173], v[170:171], v[200:201], v[168:169] op_sel_hi:[1,0,1] neg_lo:[0,0,1] neg_hi:[0,0,1]
    v_pk_fma_f32 v[192:193], v[190:191], v[200:201], v[188:189] op_sel_hi:[1,0,1] neg_lo:[0,0,1] neg_hi:[0,0,1]
    v_pk_fma_f32 v[174:175], v[172:173], v[200:201], v[170:171] op_sel_hi:[1,0,1] neg_lo:[0,0,1] neg_hi:[0,0,1]
    v_pk_fma_f32 v[194:195], v[192:193], v[200:201], v[190:191] op_sel_hi:[1,0,1] neg_lo:[0,0,1] neg_hi:[0,0,1]
    v_pk_fma_f32 v[176:177], v[174:175], v[200:201], v[172:173] op_sel_hi:[1,0,1] neg_lo:[0,0,1] neg_hi:[0,0,1]
    v_pk_fma_f32 v[196:197], v[194:195], v[200:201], v[192:193] op_sel_hi:[1,0,1] neg_lo:[0,0,1] neg_hi:[0,0,1]
    v_pk_fma_f32 v[178:179], v[176:177], v[200:201], v[174:175] op_sel_hi:[1,0,1] neg_lo:[0,0,1] neg_hi:[0,0,1]
    v_pk_fma_f32 v[198:199], v[196:197], v[200:201], v[194:195] op_sel_hi:[1,0,1] neg_lo:[0,0,1] neg_hi:[0,0,1]
    v_cvt_pk_bf16_f32 v60, v160, v162
    v_cvt_pk_bf16_f32 v120, v161, v163
    v_cvt_pk_bf16_f32 v61, v164, v166
    v_cvt_pk_bf16_f32 v121, v165, v167
    v_cvt_pk_bf16_f32 v62, v168, v170
    v_cvt_pk_bf16_f32 v122, v169, v171
    v_cvt_pk_bf16_f32 v63, v172, v174
    v_cvt_pk_bf16_f32 v123, v173, v175
    v_cvt_pk_bf16_f32 v76, v176, v178
    v_cvt_pk_bf16_f32 v136, v177, v179
    v_cvt_pk_bf16_f32 v64, v180, v182
    v_cvt_pk_bf16_f32 v124, v181, v183
    v_cvt_pk_bf16_f32 v65, v184, v186
    v_cvt_pk_bf16_f32 v125, v185, v187
    v_cvt_pk_bf16_f32 v66, v188, v190
    v_cvt_pk_bf16_f32 v126, v189, v191
    v_cvt_pk_bf16_f32 v67, v192, v194
    v_cvt_pk_bf16_f32 v127, v193, v195
    v_cvt_pk_bf16_f32 v77, v196, v198
    v_cvt_pk_bf16_f32 v137, v197, v199
    v_pk_fma_f32 v[160:161], v[180:181], v[200:201], v[160:161] op_sel:[0,1,0] op_sel_hi:[1,1,1] neg_lo:[0,0,1] neg_hi:[0,0,1]
    v_pk_fma_f32 v[162:163], v[182:183], v[200:201], v[162:163] op_sel:[0,1,0] op_sel_hi:[1,1,1] neg_lo:[0,0,1] neg_hi:[0,0,1]
    v_pk_fma_f32 v[164:165], v[184:185], v[200:201], v[164:165] op_sel:[0,1,0] op_sel_hi:[1,1,1] neg_lo:[0,0,1] neg_hi:[0,0,1]
    v_pk_fma_f32 v[166:167], v[186:187], v[200:201], v[166:167] op_sel:[0,1,0] op_sel_hi:[1,1,1] neg_lo:[0,0,1] neg_hi:[0,0,1]
    v_pk_fma_f32 v[168:169], v[188:189], v[200:201], v[168:169] op_sel:[0,1,0] op_sel_hi:[1,1,1] neg_lo:[0,0,1] neg_hi:[0,0,1]
    v_pk_fma_f32 v[170:171], v[190:191], v[200:201], v[170:171] op_sel:[0,1,0] op_sel_hi:[1,1,1] neg_lo:[0,0,1] neg_hi:[0,0,1]
    v_pk_fma_f32 v[172:173], v[192:193], v[200:201], v[172:173] op_sel:[0,1,0] op_sel_hi:[1,1,1] neg_lo:[0,0,1] neg_hi:[0,0,1]
    v_pk_fma_f32 v[174:175], v[194:195], v[200:201], v[174:175] op_sel:[0,1,0] op_sel_hi:[1,1,1] neg_lo:[0,0,1] neg_hi:[0,0,1]
    v_pk_fma_f32 v[176:177], v[196:197], v[200:201], v[176:177] op_sel:[0,1,0] op_sel_hi:[1,1,1] neg_lo:[0,0,1] neg_hi:[0,0,1]
    v_pk_fma_f32 v[178:179], v[198:199], v[200:201], v[178:179] op_sel:[0,1,0] op_sel_hi:[1,1,1] neg_lo:[0,0,1] neg_hi:[0,0,1]
    v_cvt_pk_bf16_f32 v68, v160, v162
    v_cvt_pk_bf16_f32 v128, v161, v163
    v_cvt_pk_bf16_f32 v69, v164, v166
    v_cvt_pk_bf16_f32 v129, v165, v167
    v_cvt_pk_bf16_f32 v70, v168, v170
    v_cvt_pk_bf16_f32 v130, v169, v171
    v_cvt_pk_bf16_f32 v71, v172, v174
    v_cvt_pk_bf16_f32 v131, v173, v175
    v_cvt_pk_bf16_f32 v78, v176, v178
    v_cvt_pk_bf16_f32 v138, v177, v179
    v_pk_fma_f32 v[180:181], v[160:161], v[200:201], v[180:181] op_sel:[0,1,0] op_sel_hi:[1,1,1] neg_lo:[0,0,1] neg_hi:[0,0,1]
    v_pk_fma_f32 v[182:183], v[162:163], v[200:201], v[182:183] op_sel:[0,1,0] op_sel_hi:[1,1,1] neg_lo:[0,0,1] neg_hi:[0,0,1]
    v_pk_fma_f32 v[184:185], v[164:165], v[200:201], v[184:185] op_sel:[0,1,0] op_sel_hi:[1,1,1] neg_lo:[0,0,1] neg_hi:[0,0,1]
    v_pk_fma_f32 v[186:187], v[166:167], v[200:201], v[186:187] op_sel:[0,1,0] op_sel_hi:[1,1,1] neg_lo:[0,0,1] neg_hi:[0,0,1]
    v_pk_fma_f32 v[188:189], v[168:169], v[200:201], v[188:189] op_sel:[0,1,0] op_sel_hi:[1,1,1] neg_lo:[0,0,1] neg_hi:[0,0,1]
    v_pk_fma_f32 v[190:191], v[170:171], v[200:201], v[190:191] op_sel:[0,1,0] op_sel_hi:[1,1,1] neg_lo:[0,0,1] neg_hi:[0,0,1]
    v_pk_fma_f32 v[192:193], v[172:173], v[200:201], v[192:193] op_sel:[0,1,0] op_sel_hi:[1,1,1] neg_lo:[0,0,1] neg_hi:[0,0,1]
    v_pk_fma_f32 v[194:195], v[174:175], v[200:201], v[194:195] op_sel:[0,1,0] op_sel_hi:[1,1,1] neg_lo:[0,0,1] neg_hi:[0,0,1]
    v_pk_fma_f32 v[196:197], v[176:177], v[200:201], v[196:197] op_sel:[0,1,0] op_sel_hi:[1,1,1] neg_lo:[0,0,1] neg_hi:[0,0,1]
    v_pk_fma_f32 v[198:199], v[178:179], v[200:201], v[198:199] op_sel:[0,1,0] op_sel_hi:[1,1,1] neg_lo:[0,0,1] neg_hi:[0,0,1]
    v_cvt_pk_bf16_f32 v72, v180, v182
    v_cvt_pk_bf16_f32 v132, v181, v183
    v_cvt_pk_bf16_f32 v73, v184, v186
    v_cvt_pk_bf16_f32 v133, v185, v187
    v_cvt_pk_bf16_f32 v74, v188, v190
    v_cvt_pk_bf16_f32 v134, v189, v191
    v_cvt_pk_bf16_f32 v75, v192, v194
    v_cvt_pk_bf16_f32 v135, v193, v195
    v_cvt_pk_bf16_f32 v79, v196, v198
    v_cvt_pk_bf16_f32 v139, v197, v199
    s_mov_b32 s9, 41088
    s_add_u32 m0, s8, 46080
    s_nop 0
    buffer_load_dwordx4 v36, s[44:47], s9 offen lds
    s_add_u32 m0, s8, 78848
    s_nop 0
    buffer_load_dwordx4 v36, s[48:51], s9 offen lds
    s_cmp_eq_u32 s55, 0
    s_cbranch_scc1 A_SKIP_B2
    s_add_u32 s5, s54, 2
    s_lshl_b32 s5, s5, 5
    s_add_u32 s5, s5, s53
    v_lshl_add_u32 v202, v6, 1, s5
    v_cvt_f32_u32 v202, v202
    v_mul_f32 v202, 0x3acccccd, v202
    v_cos_f32 v200, v202
    v_mul_f32 v204, 0x42200000, v202
    v_cos_f32 v201, v204
    s_nop 0
    v_pk_add_f32 v[200:201], v[200:201], v[200:201]
    v_add_f32 v204, 0x00000000, v203
    v_mul_f32 v204, v204, v202
    v_cos_f32 v160, v204
    v_sin_f32 v161, v204
    v_add_f32 v205, 0x3f800000, v203
    v_mul_f32 v205, v205, v202
    v_cos_f32 v162, v205
    v_sin_f32 v163, v205
    v_add_f32 v204, 0x42200000, v203
    v_mul_f32 v204, v204, v202
    v_cos_f32 v180, v204
    v_sin_f32 v181, v204
    v_add_f32 v205, 0x42240000, v203
    v_mul_f32 v205, v205, v202
    v_cos_f32 v182, v205
    v_sin_f32 v183, v205
    v_pk_fma_f32 v[164:165], v[162:163], v[200:201], v[160:161] op_sel_hi:[1,0,1] neg_lo:[0,0,1] neg_hi:[0,0,1]
    v_pk_fma_f32 v[184:185], v[182:183], v[200:201], v[180:181] op_sel_hi:[1,0,1] neg_lo:[0,0,1] neg_hi:[0,0,1]
    v_pk_fma_f32 v[166:167], v[164:165], v[200:201], v[162:163] op_sel_hi:[1,0,1] neg_lo:[0,0,1] neg_hi:[0,0,1]
    v_pk_fma_f32 v[186:187], v[184:185], v[200:201], v[182:183] op_sel_hi:[1,0,1] neg_lo:[0,0,1] neg_hi:[0,0,1]
    v_pk_fma_f32 v[168:169], v[166:167], v[200:201], v[164:165] op_sel_hi:[1,0,1] neg_lo:[0,0,1] neg_hi:[0,0,1]
    v_pk_fma_f32 v[188:189], v[186:187], v[200:201], v[184:185] op_sel_hi:[1,0,1] neg_lo:[0,0,1] neg_hi:[0,0,1]
    v_pk_fma_f32 v[170:171], v[168:169], v[200:201], v[166:167] op_sel_hi:[1,0,1] neg_lo:[0,0,1] neg_hi:[0,0,1]
    v_pk_fma_f32 v[190:191], v[188:189], v[200:201], v[186:187] op_sel_hi:[1,0,1] neg_lo:[0,0,1] neg_hi:[0,0,1]
    v_pk_fma_f32 v[172:173], v[170:171], v[200:201], v[168:169] op_sel_hi:[1,0,1] neg_lo:[0,0,1] neg_hi:[0,0,1]
    v_pk_fma_f32 v[192:193], v[190:191], v[200:201], v[188:189] op_sel_hi:[1,0,1] neg_lo:[0,0,1] neg_hi:[0,0,1]
    v_pk_fma_f32 v[174:175], v[172:173], v[200:201], v[170:171] op_sel_hi:[1,0,1] neg_lo:[0,0,1] neg_hi:[0,0,1]
    v_pk_fma_f32 v[194:195], v[192:193], v[200:201], v[190:191] op_sel_hi:[1,0,1] neg_lo:[0,0,1] neg_hi:[0,0,1]
    v_pk_fma_f32 v[176:177], v[174:175], v[200:201], v[172:173] op_sel_hi:[1,0,1] neg_lo:[0,0,1] neg_hi:[0,0,1]
    v_pk_fma_f32 v[196:197], v[194:195], v[200:201], v[192:193] op_sel_hi:[1,0,1] neg_lo:[0,0,1] neg_hi:[0,0,1]
    v_pk_fma_f32 v[178:179], v[176:177], v[200:201], v[174:175] op_sel_hi:[1,0,1] neg_lo:[0,0,1] neg_hi:[0,0,1]
    v_pk_fma_f32 v[198:199], v[196:197], v[200:201], v[194:195] op_sel_hi:[1,0,1] neg_lo:[0,0,1] neg_hi:[0,0,1]
    v_cvt_pk_bf16_f32 v80, v160, v162
    v_cvt_pk_bf16_f32 v140, v161, v163
    v_cvt_pk_bf16_f32 v81, v164, v166
    v_cvt_pk_bf16_f32 v141, v165, v167
    v_cvt_pk_bf16_f32 v82, v168, v170
    v_cvt_pk_bf16_f32 v142, v169, v171
    v_cvt_pk_bf16_f32 v83, v172, v174
    v_cvt_pk_bf16_f32 v143, v173, v175
    v_cvt_pk_bf16_f32 v96, v176, v178
    v_cvt_pk_bf16_f32 v156, v177, v179
    v_cvt_pk_bf16_f32 v84, v180, v182
    v_cvt_pk_bf16_f32 v144, v181, v183
    v_cvt_pk_bf16_f32 v85, v184, v186
    v_cvt_pk_bf16_f32 v145, v185, v187
    v_cvt_pk_bf16_f32 v86, v188, v190
    v_cvt_pk_bf16_f32 v146, v189, v191
    v_cvt_pk_bf16_f32 v87, v192, v194
    v_cvt_pk_bf16_f32 v147, v193, v195
    v_cvt_pk_bf16_f32 v97, v196, v198
    v_cvt_pk_bf16_f32 v157, v197, v199
    v_pk_fma_f32 v[160:161], v[180:181], v[200:201], v[160:161] op_sel:[0,1,0] op_sel_hi:[1,1,1] neg_lo:[0,0,1] neg_hi:[0,0,1]
    v_pk_fma_f32 v[162:163], v[182:183], v[200:201], v[162:163] op_sel:[0,1,0] op_sel_hi:[1,1,1] neg_lo:[0,0,1] neg_hi:[0,0,1]
    v_pk_fma_f32 v[164:165], v[184:185], v[200:201], v[164:165] op_sel:[0,1,0] op_sel_hi:[1,1,1] neg_lo:[0,0,1] neg_hi:[0,0,1]
    v_pk_fma_f32 v[166:167], v[186:187], v[200:201], v[166:167] op_sel:[0,1,0] op_sel_hi:[1,1,1] neg_lo:[0,0,1] neg_hi:[0,0,1]
    v_pk_fma_f32 v[168:169], v[188:189], v[200:201], v[168:169] op_sel:[0,1,0] op_sel_hi:[1,1,1] neg_lo:[0,0,1] neg_hi:[0,0,1]
    v_pk_fma_f32 v[170:171], v[190:191], v[200:201], v[170:171] op_sel:[0,1,0] op_sel_hi:[1,1,1] neg_lo:[0,0,1] neg_hi:[0,0,1]
    v_pk_fma_f32 v[172:173], v[192:193], v[200:201], v[172:173] op_sel:[0,1,0] op_sel_hi:[1,1,1] neg_lo:[0,0,1] neg_hi:[0,0,1]
    v_pk_fma_f32 v[174:175], v[194:195], v[200:201], v[174:175] op_sel:[0,1,0] op_sel_hi:[1,1,1] neg_lo:[0,0,1] neg_hi:[0,0,1]
    v_pk_fma_f32 v[176:177], v[196:197], v[200:201], v[176:177] op_sel:[0,1,0] op_sel_hi:[1,1,1] neg_lo:[0,0,1] neg_hi:[0,0,1]
    v_pk_fma_f32 v[178:179], v[198:199], v[200:201], v[178:179] op_sel:[0,1,0] op_sel_hi:[1,1,1] neg_lo:[0,0,1] neg_hi:[0,0,1]
    v_cvt_pk_bf16_f32 v88, v160, v162
    v_cvt_pk_bf16_f32 v148, v161, v163
    v_cvt_pk_bf16_f32 v89, v164, v166
    v_cvt_pk_bf16_f32 v149, v165, v167
    v_cvt_pk_bf16_f32 v90, v168, v170
    v_cvt_pk_bf16_f32 v150, v169, v171
    v_cvt_pk_bf16_f32 v91, v172, v174
    v_cvt_pk_bf16_f32 v151, v173, v175
    v_cvt_pk_bf16_f32 v98, v176, v178
    v_cvt_pk_bf16_f32 v158, v177, v179
    v_pk_fma_f32 v[180:181], v[160:161], v[200:201], v[180:181] op_sel:[0,1,0] op_sel_hi:[1,1,1] neg_lo:[0,0,1] neg_hi:[0,0,1]
    v_pk_fma_f32 v[182:183], v[162:163], v[200:201], v[182:183] op_sel:[0,1,0] op_sel_hi:[1,1,1] neg_lo:[0,0,1] neg_hi:[0,0,1]
    v_pk_fma_f32 v[184:185], v[164:165], v[200:201], v[184:185] op_sel:[0,1,0] op_sel_hi:[1,1,1] neg_lo:[0,0,1] neg_hi:[0,0,1]
    v_pk_fma_f32 v[186:187], v[166:167], v[200:201], v[186:187] op_sel:[0,1,0] op_sel_hi:[1,1,1] neg_lo:[0,0,1] neg_hi:[0,0,1]
    v_pk_fma_f32 v[188:189], v[168:169], v[200:201], v[188:189] op_sel:[0,1,0] op_sel_hi:[1,1,1] neg_lo:[0,0,1] neg_hi:[0,0,1]
    v_pk_fma_f32 v[190:191], v[170:171], v[200:201], v[190:191] op_sel:[0,1,0] op_sel_hi:[1,1,1] neg_lo:[0,0,1] neg_hi:[0,0,1]
    v_pk_fma_f32 v[192:193], v[172:173], v[200:201], v[192:193] op_sel:[0,1,0] op_sel_hi:[1,1,1] neg_lo:[0,0,1] neg_hi:[0,0,1]
    v_pk_fma_f32 v[194:195], v[174:175], v[200:201], v[194:195] op_sel:[0,1,0] op_sel_hi:[1,1,1] neg_lo:[0,0,1] neg_hi:[0,0,1]
    v_pk_fma_f32 v[196:197], v[176:177], v[200:201], v[196:197] op_sel:[0,1,0] op_sel_hi:[1,1,1] neg_lo:[0,0,1] neg_hi:[0,0,1]
    v_pk_fma_f32 v[198:199], v[178:179], v[200:201], v[198:199] op_sel:[0,1,0] op_sel_hi:[1,1,1] neg_lo:[0,0,1] neg_hi:[0,0,1]
    v_cvt_pk_bf16_f32 v92, v180, v182
    v_cvt_pk_bf16_f32 v152, v181, v183
    v_cvt_pk_bf16_f32 v93, v184, v186
    v_cvt_pk_bf16_f32 v153, v185, v187
    v_cvt_pk_bf16_f32 v94, v188, v190
    v_cvt_pk_bf16_f32 v154, v189, v191
    v_cvt_pk_bf16_f32 v95, v192, v194
    v_cvt_pk_bf16_f32 v155, v193, v195
    v_cvt_pk_bf16_f32 v99, v196, v198
    v_cvt_pk_bf16_f32 v159, v197, v199
A_SKIP_B2:
    s_nop 1
    s_mov_b32 s56, 0xffff0000
    v_mul_u32_u24 v2, 1280, v7
    v_add_u32 v2, s13, v2
    v_mul_u32_u24 v3, 20, v5
    v_add_u32 v4, v2, v3
    v_sub_u32 v3, v2, v3
    v_add_u32 v3, 620, v3
    s_waitcnt vmcnt(4)
    ds_read2_b32 v[12:13], v4 offset0:0 offset1:1
    ds_read2_b32 v[14:15], v4 offset0:2 offset1:3
    ds_read_b32 v16, v4 offset:16
    ds_read2_b32 v[24:25], v3 offset0:160 offset1:161
    ds_read2_b32 v[26:27], v3 offset0:162 offset1:163
    ds_read2_b32 v[28:29], v3 offset0:164 offset1:165
    ds_read2_b32 v[30:31], v3 offset0:0 offset1:1
    ds_read2_b32 v[32:33], v3 offset0:2 offset1:3
    ds_read2_b32 v[34:35], v3 offset0:4 offset1:5
    ds_read2_b32 v[18:19], v4 offset0:160 offset1:161
    ds_read2_b32 v[20:21], v4 offset0:162 offset1:163
    ds_read_b32 v22, v4 offset:656
    s_waitcnt lgkmcnt(0)
    v_lshlrev_b32 v160, 16, v12
    v_lshlrev_b32 v170, 16, v18
    v_lshlrev_b32 v180, 16, v29
    v_lshlrev_b32 v190, 16, v35
    v_and_b32 v161, s56, v12
    v_and_b32 v171, s56, v18
    v_and_b32 v181, s56, v28
    v_and_b32 v191, s56, v34
    v_lshlrev_b32 v162, 16, v13
    v_lshlrev_b32 v172, 16, v19
    v_lshlrev_b32 v182, 16, v28
    v_lshlrev_b32 v192, 16, v34
    v_and_b32 v163, s56, v13
    v_and_b32 v173, s56, v19
    v_and_b32 v183, s56, v27
    v_and_b32 v193, s56, v33
    v_lshlrev_b32 v164, 16, v14
    v_lshlrev_b32 v174, 16, v20
    v_lshlrev_b32 v184, 16, v27
    v_lshlrev_b32 v194, 16, v33
    v_and_b32 v165, s56, v14
    v_and_b32 v175, s56, v20
    v_and_b32 v185, s56, v26
    v_and_b32 v195, s56, v32
    v_lshlrev_b32 v166, 16, v15
    v_lshlrev_b32 v176, 16, v21
    v_lshlrev_b32 v186, 16, v26
    v_lshlrev_b32 v196, 16, v32
    v_and_b32 v167, s56, v15
    v_and_b32 v177, s56, v21
    v_and_b32 v187, s56, v25
    v_and_b32 v197, s56, v31
    v_lshlrev_b32 v168, 16, v16
    v_lshlrev_b32 v178, 16, v22
    v_lshlrev_b32 v188, 16, v25
    v_lshlrev_b32 v198, 16, v31
    v_and_b32 v169, s56, v16
    v_and_b32 v179, s56, v22
    v_and_b32 v189, s56, v24
    v_and_b32 v199, s56, v30
    v_lshlrev_b32 v200, 16, v24
    v_lshlrev_b32 v201, 16, v30
    v_cmp_eq_u32 s[58:59], 15, v5
    v_cmp_ne_u32 s[64:65], 0, v5
    s_nop 1
    v_cndmask_b32 v180, 0, v180, s[64:65]
    v_cndmask_b32 v190, 0, v190, s[64:65]
    v_add_f32 v206, v160, v180
    v_sub_f32 v160, v160, v180
    v_add_f32 v208, v190, v170
    v_sub_f32 v170, v170, v190
    v_add_f32 v180, v206, v208
    v_sub_f32 v190, v206, v208
    v_add_f32 v206, v160, v170
    v_sub_f32 v170, v160, v170
    v_mov_b32 v202, v180
    v_mov_b32 v160, v206
    v_add_f32 v207, v161, v181
    v_sub_f32 v161, v161, v181
    v_add_f32 v209, v191, v171
    v_sub_f32 v171, v171, v191
    v_add_f32 v181, v207, v209
    v_sub_f32 v191, v207, v209
    v_add_f32 v207, v161, v171
    v_sub_f32 v171, v161, v171
    v_mov_b32 v203, v181
    v_mov_b32 v161, v207
    v_add_f32 v206, v162, v182
    v_sub_f32 v162, v162, v182
    v_add_f32 v208, v192, v172
    v_sub_f32 v172, v172, v192
    v_add_f32 v182, v206, v208
    v_sub_f32 v192, v206, v208
    v_add_f32 v206, v162, v172
    v_sub_f32 v172, v162, v172
    v_add_f32 v202, v202, v182
    v_mov_b32 v162, v206
    v_add_f32 v207, v163, v183
    v_sub_f32 v163, v163, v183
    v_add_f32 v209, v193, v173
    v_sub_f32 v173, v173, v193
    v_add_f32 v183, v207, v209
    v_sub_f32 v193, v207, v209
    v_add_f32 v207, v163, v173
    v_sub_f32 v173, v163, v173
    v_add_f32 v203, v203, v183
    v_mov_b32 v163, v207
    v_add_f32 v206, v164, v184
    v_sub_f32 v164, v164, v184
    v_add_f32 v208, v194, v174
    v_sub_f32 v174, v174, v194
    v_add_f32 v184, v206, v208
    v_sub_f32 v194, v206, v208
    v_add_f32 v206, v164, v174
    v_sub_f32 v174, v164, v174
    v_add_f32 v202, v202, v184
    v_mov_b32 v164, v206
    v_add_f32 v207, v165, v185
    v_sub_f32 v165, v165, v185
    v_add_f32 v209, v195, v175
    v_sub_f32 v175, v175, v195
    v_add_f32 v185, v207, v209
    v_sub_f32 v195, v207, v209
    v_add_f32 v207, v165, v175
    v_sub_f32 v175, v165, v175
    v_add_f32 v203, v203, v185
    v_mov_b32 v165, v207
    v_add_f32 v206, v166, v186
    v_sub_f32 v166, v166, v186
    v_add_f32 v208, v196, v176
    v_sub_f32 v176, v176, v196
    v_add_f32 v186, v206, v208
    v_sub_f32 v196, v206, v208
    v_add_f32 v206, v166, v176
    v_sub_f32 v176, v166, v176
    v_add_f32 v202, v202, v186
    v_mov_b32 v166, v206
    v_add_f32 v207, v167, v187
    v_sub_f32 v167, v167, v187
    v_add_f32 v209, v197, v177
    v_sub_f32 v177, v177, v197
    v_add_f32 v187, v207, v209
    v_sub_f32 v197, v207, v209
    v_add_f32 v207, v167, v177
    v_sub_f32 v177, v167, v177
    v_add_f32 v203, v203, v187
    v_mov_b32 v167, v207
    v_add_f32 v206, v168, v188
    v_sub_f32 v168, v168, v188
    v_add_f32 v208, v198, v178
    v_sub_f32 v178, v178, v198
    v_add_f32 v188, v206, v208
    v_sub_f32 v198, v206, v208
    v_add_f32 v206, v168, v178
    v_sub_f32 v178, v168, v178
    v_add_f32 v202, v202, v188
    v_mov_b32 v168, v206
    v_add_f32 v207, v169, v189
    v_sub_f32 v169, v169, v189
    v_add_f32 v209, v199, v179
    v_sub_f32 v179, v179, v199
    v_add_f32 v189, v207, v209
    v_sub_f32 v199, v207, v209
    v_add_f32 v207, v169, v179
    v_sub_f32 v179, v169, v179
    v_add_f32 v203, v203, v189
    v_mov_b32 v169, v207
    v_add_f32 v210, v200, v201
    v_sub_f32 v211, v201, v200
    v_cndmask_b32 v210, 0, v210, s[58:59]
    v_cndmask_b32 v211, 0, v211, s[58:59]
    v_add_f32 v202, v202, v210
    v_sub_f32 v212, v202, v203
    v_add_f32 v202, v202, v203
    s_nop 1
    v_add_f32_dpp v202, v202, v202 quad_perm:[1,0,3,2] row_mask:0xf bank_mask:0xf
    s_nop 1
    v_add_f32_dpp v202, v202, v202 quad_perm:[2,3,0,1] row_mask:0xf bank_mask:0xf
    s_nop 1
    v_add_f32_dpp v202, v202, v202 row_half_mirror row_mask:0xf bank_mask:0xf
    s_nop 1
    v_add_f32_dpp v202, v202, v202 row_mirror row_mask:0xf bank_mask:0xf
    v_add_f32_dpp v212, v212, v212 quad_perm:[1,0,3,2] row_mask:0xf bank_mask:0xf
    s_nop 1
    v_add_f32_dpp v212, v212, v212 quad_perm:[2,3,0,1] row_mask:0xf bank_mask:0xf
    s_nop 1
    v_add_f32_dpp v212, v212, v212 row_half_mirror row_mask:0xf bank_mask:0xf
    s_nop 1
    v_add_f32_dpp v212, v212, v212 row_mirror row_mask:0xf bank_mask:0xf
    v_mul_f32 v204, 0x3acccccd, v202
    v_mul_f32 v206, 4.0, v204
    v_add_f32 v207, v204, v204
    v_cndmask_b32 v208, v207, v206, s[64:65]
    v_cndmask_b32 v209, v207, 0, s[64:65]
    v_sub_f32 v180, v180, v208
    v_sub_f32 v160, v160, v209
    v_cndmask_b32 v208, 0, v207, s[58:59]
    v_sub_f32 v210, v210, v208
    v_sub_f32 v181, v181, v206
    v_sub_f32 v182, v182, v206
    v_sub_f32 v183, v183, v206
    v_sub_f32 v184, v184, v206
    v_sub_f32 v185, v185, v206
    v_sub_f32 v186, v186, v206
    v_sub_f32 v187, v187, v206
    v_sub_f32 v188, v188, v206
    v_sub_f32 v189, v189, v206
    v_mul_f32 v202, v210, v210
    v_mul_f32 v203, v211, v211
    v_add_f32 v202, v202, v202
    v_add_f32 v203, v203, v203
    v_mul_f32 v208, v180, v180
    v_mul_f32 v209, v190, v190
    v_fmac_f32 v202, v181, v181
    v_fmac_f32 v203, v182, v182
    v_fmac_f32 v208, v183, v183
    v_fmac_f32 v209, v184, v184
    v_fmac_f32 v202, v185, v185
    v_fmac_f32 v203, v186, v186
    v_fmac_f32 v208, v187, v187
    v_fmac_f32 v209, v188, v188
    v_fmac_f32 v202, v189, v189
    v_fmac_f32 v203, v191, v191
    v_fmac_f32 v208, v192, v192
    v_fmac_f32 v209, v193, v193
    v_fmac_f32 v202, v194, v194
    v_fmac_f32 v203, v195, v195
    v_fmac_f32 v208, v196, v196
    v_fmac_f32 v209, v197, v197
    v_fmac_f32 v202, v198, v198
    v_fmac_f32 v203, v199, v199
    v_fmac_f32 v208, v160, v160
    v_fmac_f32 v209, v161, v161
    v_fmac_f32 v202, v162, v162
    v_fmac_f32 v203, v163, v163
    v_fmac_f32 v208, v164, v164
    v_fmac_f32 v209, v165, v165
    v_fmac_f32 v202, v166, v166
    v_fmac_f32 v203, v167, v167
    v_fmac_f32 v208, v168, v168
    v_fmac_f32 v209, v169, v169
    v_fmac_f32 v202, v170, v170
    v_fmac_f32 v203, v171, v171
    v_fmac_f32 v208, v172, v172
    v_fmac_f32 v209, v173, v173
    v_fmac_f32 v202, v174, v174
    v_fmac_f32 v203, v175, v175
    v_fmac_f32 v208, v176, v176
    v_fmac_f32 v209, v177, v177
    v_fmac_f32 v202, v178, v178
    v_fmac_f32 v203, v179, v179
    v_add_f32 v202, v202, v203
    v_add_f32 v208, v208, v209
    v_add_f32 v202, v202, v208
    s_nop 1
    v_add_f32_dpp v202, v202, v202 quad_perm:[1,0,3,2] row_mask:0xf bank_mask:0xf
    s_nop 1
    v_add_f32_dpp v202, v202, v202 quad_perm:[2,3,0,1] row_mask:0xf bank_mask:0xf
    s_nop 1
    v_add_f32_dpp v202, v202, v202 row_half_mirror row_mask:0xf bank_mask:0xf
    s_nop 1
    v_add_f32_dpp v202, v202, v202 row_mirror row_mask:0xf bank_mask:0xf
    v_mul_f32 v202, 0x39cccccd, v202
    v_cvt_pk_bf16_f32 v205, v204, v204
    v_and_b32 v205, 0xffff0000, v205
    v_cvt_pk_bf16_f32 v2, v202, v202
    v_and_b32 v2, 0xffff0000, v2
    v_add_f32 v2, 0x3727c5ac, v2
    v_cvt_pk_bf16_f32 v2, v2, v2
    v_and_b32 v2, 0xffff0000, v2
    v_sqrt_f32 v2, v2
    s_nop 0
    v_cvt_pk_bf16_f32 v2, v2, v2
    v_and_b32 v2, 0xffff0000, v2
    v_rcp_f32 v214, v2
    s_nop 0
    v_mul_f32 v214, 0x35cccccd, v214
    v_sub_f32 v204, v204, v205
    v_mul_f32 v204, v204, v214
    v_mul_f32 v215, 4.0, v204
    v_add_f32 v204, v204, v204
    v_cndmask_b32 v206, v204, v215, s[64:65]
    v_fma_f32 v180, v180, v214, v206
    v_mul_f32 v190, v190, v214
    v_mul_f32 v160, v160, v214
    v_mul_f32 v170, v170, v214
    v_fma_f32 v181, v181, v214, v215
    v_mul_f32 v191, v191, v214
    v_mul_f32 v161, v161, v214
    v_mul_f32 v171, v171, v214
    v_cvt_pk_bf16_f32 v12, v180, v181
    v_cvt_pk_bf16_f32 v18, v190, v191
    v_cvt_pk_bf16_f32 v24, v160, v161
    v_cvt_pk_bf16_f32 v30, v170, v171
    v_fma_f32 v182, v182, v214, v215
    v_mul_f32 v192, v192, v214
    v_mul_f32 v162, v162, v214
    v_mul_f32 v172, v172, v214
    v_fma_f32 v183, v183, v214, v215
    v_mul_f32 v193, v193, v214
    v_mul_f32 v163, v163, v214
    v_mul_f32 v173, v173, v214
    v_cvt_pk_bf16_f32 v13, v182, v183
    v_cvt_pk_bf16_f32 v19, v192, v193
    v_cvt_pk_bf16_f32 v25, v162, v163
    v_cvt_pk_bf16_f32 v31, v172, v173
    v_fma_f32 v184, v184, v214, v215
    v_mul_f32 v194, v194, v214
    v_mul_f32 v164, v164, v214
    v_mul_f32 v174, v174, v214
    v_fma_f32 v185, v185, v214, v215
    v_mul_f32 v195, v195, v214
    v_mul_f32 v165, v165, v214
    v_mul_f32 v175, v175, v214
    v_cvt_pk_bf16_f32 v14, v184, v185
    v_cvt_pk_bf16_f32 v20, v194, v195
    v_cvt_pk_bf16_f32 v26, v164, v165
    v_cvt_pk_bf16_f32 v32, v174, v175
    v_fma_f32 v186, v186, v214, v215
    v_mul_f32 v196, v196, v214
    v_mul_f32 v166, v166, v214
    v_mul_f32 v176, v176, v214
    v_fma_f32 v187, v187, v214, v215
    v_mul_f32 v197, v197, v214
    v_mul_f32 v167, v167, v214
    v_mul_f32 v177, v177, v214
    v_cvt_pk_bf16_f32 v15, v186, v187
    v_cvt_pk_bf16_f32 v21, v196, v197
    v_cvt_pk_bf16_f32 v27, v166, v167
    v_cvt_pk_bf16_f32 v33, v176, v177
    v_fma_f32 v188, v188, v214, v215
    v_mul_f32 v198, v198, v214
    v_mul_f32 v168, v168, v214
    v_mul_f32 v178, v178, v214
    v_fma_f32 v189, v189, v214, v215
    v_mul_f32 v199, v199, v214
    v_mul_f32 v169, v169, v214
    v_mul_f32 v179, v179, v214
    v_cvt_pk_bf16_f32 v16, v188, v189
    v_cvt_pk_bf16_f32 v22, v198, v199
    v_cvt_pk_bf16_f32 v28, v168, v169
    v_cvt_pk_bf16_f32 v34, v178, v179
    v_mul_u32_u24 v2, 1360, v8
    v_lshl_add_u32 v3, v5, 4, v2
    v_and_b32 v4, 3, v5
    v_lshl_add_u32 v2, v4, 4, v2
    v_lshrrev_b32 v4, 2, v5
    v_lshl_add_u32 v2, v4, 2, v2
    ds_write_b128 v3, v[12:15] offset:0
    ds_write_b32 v2, v16 offset:256
    ds_write_b128 v3, v[18:21] offset:336
    ds_write_b32 v2, v22 offset:592
    ds_write_b128 v3, v[24:27] offset:672
    ds_write_b32 v2, v28 offset:928
    ds_write_b128 v3, v[30:33] offset:1008
    ds_write_b32 v2, v34 offset:1264
    v_mul_f32 v212, v212, v214
    v_fma_f32 v210, v210, v214, v204
    v_mul_f32 v211, v211, v214
    v_mov_b32 v208, 0
    v_lshlrev_b32 v2, 2, v8
    s_mov_b64 exec, s[58:59]
    ds_write_b32 v2, v210 offset:43520
    ds_write_b32 v2, v211 offset:43648
    ds_write_b32 v2, v208 offset:43776
    ds_write_b32 v2, v212 offset:43904
    s_mov_b64 exec, -1
    s_cmp_ge_u32 s4, 4
    s_cbranch_scc1 A_NODMA
A_NODMA:
    s_mov_b32 s9, 82176
    s_add_u32 m0, s8, 47104
    s_nop 0
    buffer_load_dwordx4 v36, s[44:47], s9 offen lds
    s_add_u32 m0, s8, 79872
    s_nop 0
    buffer_load_dwordx4 v36, s[48:51], s9 offen lds
    s_waitcnt lgkmcnt(0)
    s_barrier
    s_mul_i32 s5, s53, 336
    v_mul_u32_u24 v216, 1360, v6
    v_lshl_add_u32 v216, v7, 4, v216
    v_add_u32 v216, s5, v216
    s_lshl_b32 s5, s53, 8
    s_lshl_b32 s6, s53, 7
    s_sub_u32 s6, 256, s6
    v_lshl_add_u32 v2, v7, 4, s5
    v_lshl_add_u32 v3, v7, 4, s6
    ds_read_b128 v[176:179], v2 offset:43520
    ds_read_b128 v[200:203], v3 offset:43520
    ds_read_b128 v[180:183], v2 offset:43584
    ds_read_b128 v[204:207], v3 offset:43584
    ds_read_b128 v[12:15], v216 offset:0
    ds_read_b128 v[16:19], v216 offset:21760
    ds_read_b128 v[20:23], v216 offset:672
    ds_read_b128 v[24:27], v216 offset:22432
    v_lshlrev_b32 v217, 31, v6
    s_waitcnt lgkmcnt(4)
    v_xor_b32 v176, v217, v176
    v_xor_b32 v200, v217, v200
    v_xor_b32 v177, v217, v177
    v_xor_b32 v201, v217, v201
    v_xor_b32 v178, v217, v178
    v_xor_b32 v202, v217, v202
    v_xor_b32 v179, v217, v179
    v_xor_b32 v203, v217, v203
    v_xor_b32 v180, v217, v180
    v_xor_b32 v204, v217, v204
    v_xor_b32 v181, v217, v181
    v_xor_b32 v205, v217, v205
    v_xor_b32 v182, v217, v182
    v_xor_b32 v206, v217, v206
    v_xor_b32 v183, v217, v183
    v_xor_b32 v207, v217, v207
    ds_read_b128 v[28:31], v216 offset:64
    ds_read_b128 v[32:35], v216 offset:21824
    ds_read_b128 v[208:211], v216 offset:736
    ds_read_b128 v[212:215], v216 offset:22496
    s_waitcnt lgkmcnt(4)
    v_mfma_f32_16x16x32_bf16 v[160:163], v[12:15], v[40:43], v[176:179]
    v_mfma_f32_16x16x32_bf16 v[184:187], v[20:23], v[100:103], v[200:203]
    v_mfma_f32_16x16x32_bf16 v[164:167], v[16:19], v[40:43], v[180:183]
    v_mfma_f32_16x16x32_bf16 v[188:191], v[24:27], v[100:103], v[204:207]
    v_mfma_f32_16x16x32_bf16 v[168:171], v[12:15], v[60:63], v[176:179]
    v_mfma_f32_16x16x32_bf16 v[192:195], v[20:23], v[120:123], v[200:203]
    v_mfma_f32_16x16x32_bf16 v[172:175], v[16:19], v[60:63], v[180:183]
    v_mfma_f32_16x16x32_bf16 v[196:199], v[24:27], v[120:123], v[204:207]
    s_cmp_eq_u32 s55, 0
    s_cbranch_scc1 A_SKIP_M0
    v_mfma_f32_16x16x32_bf16 v[176:179], v[12:15], v[80:83], v[176:179]
    v_mfma_f32_16x16x32_bf16 v[200:203], v[20:23], v[140:143], v[200:203]
    v_mfma_f32_16x16x32_bf16 v[180:183], v[16:19], v[80:83], v[180:183]
    v_mfma_f32_16x16x32_bf16 v[204:207], v[24:27], v[140:143], v[204:207]
A_SKIP_M0:
    ds_read_b128 v[12:15], v216 offset:128
    ds_read_b128 v[16:19], v216 offset:21888
    ds_read_b128 v[20:23], v216 offset:800
    ds_read_b128 v[24:27], v216 offset:22560
    s_waitcnt lgkmcnt(4)
    v_mfma_f32_16x16x32_bf16 v[160:163], v[28:31], v[44:47], v[160:163]
    v_mfma_f32_16x16x32_bf16 v[184:187], v[208:211], v[104:107], v[184:187]
    v_mfma_f32_16x16x32_bf16 v[164:167], v[32:35], v[44:47], v[164:167]
    v_mfma_f32_16x16x32_bf16 v[188:191], v[212:215], v[104:107], v[188:191]
    v_mfma_f32_16x16x32_bf16 v[168:171], v[28:31], v[64:67], v[168:171]
    v_mfma_f32_16x16x32_bf16 v[192:195], v[208:211], v[124:127], v[192:195]
    v_mfma_f32_16x16x32_bf16 v[172:175], v[32:35], v[64:67], v[172:175]
    v_mfma_f32_16x16x32_bf16 v[196:199], v[212:215], v[124:127], v[196:199]
    s_mov_b32 s9, 123264
    s_add_u32 m0, s8, 48128
    s_nop 0
    buffer_load_dwordx4 v36, s[44:47], s9 offen lds
    s_add_u32 m0, s8, 80896
    s_nop 0
    buffer_load_dwordx4 v36, s[48:51], s9 offen lds
    s_cmp_eq_u32 s55, 0
    s_cbranch_scc1 A_SKIP_M1
    v_mfma_f32_16x16x32_bf16 v[176:179], v[28:31], v[84:87], v[176:179]
    v_mfma_f32_16x16x32_bf16 v[200:203], v[208:211], v[144:147], v[200:203]
    v_mfma_f32_16x16x32_bf16 v[180:183], v[32:35], v[84:87], v[180:183]
    v_mfma_f32_16x16x32_bf16 v[204:207], v[212:215], v[144:147], v[204:207]
A_SKIP_M1:
    ds_read_b128 v[28:31], v216 offset:192
    ds_read_b128 v[32:35], v216 offset:21952
    ds_read_b128 v[208:211], v216 offset:864
    ds_read_b128 v[212:215], v216 offset:22624
    s_waitcnt lgkmcnt(4)
    v_mfma_f32_16x16x32_bf16 v[160:163], v[12:15], v[48:51], v[160:163]
    v_mfma_f32_16x16x32_bf16 v[184:187], v[20:23], v[108:111], v[184:187]
    v_mfma_f32_16x16x32_bf16 v[164:167], v[16:19], v[48:51], v[164:167]
    v_mfma_f32_16x16x32_bf16 v[188:191], v[24:27], v[108:111], v[188:191]
    v_mfma_f32_16x16x32_bf16 v[168:171], v[12:15], v[68:71], v[168:171]
    v_mfma_f32_16x16x32_bf16 v[192:195], v[20:23], v[128:131], v[192:195]
    v_mfma_f32_16x16x32_bf16 v[172:175], v[16:19], v[68:71], v[172:175]
    v_mfma_f32_16x16x32_bf16 v[196:199], v[24:27], v[128:131], v[196:199]
    s_cmp_eq_u32 s55, 0
    s_cbranch_scc1 A_SKIP_M2
    v_mfma_f32_16x16x32_bf16 v[176:179], v[12:15], v[88:91], v[176:179]
    v_mfma_f32_16x16x32_bf16 v[200:203], v[20:23], v[148:151], v[200:203]
    v_mfma_f32_16x16x32_bf16 v[180:183], v[16:19], v[88:91], v[180:183]
    v_mfma_f32_16x16x32_bf16 v[204:207], v[24:27], v[148:151], v[204:207]
A_SKIP_M2:
    ds_read_b128 v[12:15], v216 offset:256
    ds_read_b128 v[16:19], v216 offset:22016
    ds_read_b128 v[20:23], v216 offset:928
    ds_read_b128 v[24:27], v216 offset:22688
    s_waitcnt lgkmcnt(4)
    v_mfma_f32_16x16x32_bf16 v[160:163], v[28:31], v[52:55], v[160:163]
    v_mfma_f32_16x16x32_bf16 v[184:187], v[208:211], v[112:115], v[184:187]
    v_mfma_f32_16x16x32_bf16 v[164:167], v[32:35], v[52:55], v[164:167]
    v_mfma_f32_16x16x32_bf16 v[188:191], v[212:215], v[112:115], v[188:191]
    v_mfma_f32_16x16x32_bf16 v[168:171], v[28:31], v[72:75], v[168:171]
    v_mfma_f32_16x16x32_bf16 v[192:195], v[208:211], v[132:135], v[192:195]
    v_mfma_f32_16x16x32_bf16 v[172:175], v[32:35], v[72:75], v[172:175]
    v_mfma_f32_16x16x32_bf16 v[196:199], v[212:215], v[132:135], v[196:199]
    s_cmp_eq_u32 s55, 0
    s_cbranch_scc1 A_SKIP_M3
    v_mfma_f32_16x16x32_bf16 v[176:179], v[28:31], v[92:95], v[176:179]
    v_mfma_f32_16x16x32_bf16 v[200:203], v[208:211], v[152:155], v[200:203]
    v_mfma_f32_16x16x32_bf16 v[180:183], v[32:35], v[92:95], v[180:183]
    v_mfma_f32_16x16x32_bf16 v[204:207], v[212:215], v[152:155], v[204:207]
A_SKIP_M3:
    s_waitcnt lgkmcnt(0)
    v_mfma_f32_16x16x32_bf16 v[160:163], v[12:15], v[56:59], v[160:163]
    v_mfma_f32_16x16x32_bf16 v[184:187], v[20:23], v[116:119], v[184:187]
    v_mfma_f32_16x16x32_bf16 v[164:167], v[16:19], v[56:59], v[164:167]
    v_mfma_f32_16x16x32_bf16 v[188:191], v[24:27], v[116:119], v[188:191]
    v_mfma_f32_16x16x32_bf16 v[168:171], v[12:15], v[76:79], v[168:171]
    v_mfma_f32_16x16x32_bf16 v[192:195], v[20:23], v[136:139], v[192:195]
    v_mfma_f32_16x16x32_bf16 v[172:175], v[16:19], v[76:79], v[172:175]
    v_mfma_f32_16x16x32_bf16 v[196:199], v[24:27], v[136:139], v[196:199]
    s_cmp_eq_u32 s55, 0
    s_cbranch_scc1 A_SKIP_M4
    v_mfma_f32_16x16x32_bf16 v[176:179], v[12:15], v[96:99], v[176:179]
    v_mfma_f32_16x16x32_bf16 v[200:203], v[20:23], v[156:159], v[200:203]
    v_mfma_f32_16x16x32_bf16 v[180:183], v[16:19], v[96:99], v[180:183]
    v_mfma_f32_16x16x32_bf16 v[204:207], v[24:27], v[156:159], v[204:207]
A_SKIP_M4:
    v_lshlrev_b32 v2, 4, v1
    v_add_u32 v2, 151552, v2
    ds_read_b128 v[220:223], v2 offset:0
    ds_read_b128 v[236:239], v2 offset:1024
    ds_read_b128 v[224:227], v2 offset:2048
    ds_read_b128 v[240:243], v2 offset:3072
    ds_read_b128 v[228:231], v2 offset:4096
    ds_read_b128 v[244:247], v2 offset:5120
    ds_read_b128 v[232:235], v2 offset:6144
    ds_read_b128 v[248:251], v2 offset:7168
    s_mul_i32 s5, s52, 41984
    s_mul_i32 s6, s53, 2624
    s_add_u32 s5, s5, s6
    s_lshl_b32 s6, s54, 8
    s_add_u32 s5, s5, s6
    v_mul_u32_u24 v252, 5248, v7
    v_lshl_add_u32 v252, v6, 4, v252
    v_add_u32 v252, s5, v252
    s_mov_b32 s7, 20992
    s_nop 7
    v_cvt_pk_bf16_f32 v40, v160, v184
    v_cvt_pk_bf16_f32 v41, v161, v185
    v_cvt_pk_bf16_f32 v42, v162, v186
    v_cvt_pk_bf16_f32 v43, v163, v187
    v_cvt_pk_bf16_f32 v44, v164, v188
    v_cvt_pk_bf16_f32 v45, v165, v189
    v_cvt_pk_bf16_f32 v46, v166, v190
    v_cvt_pk_bf16_f32 v47, v167, v191
    v_cvt_pk_bf16_f32 v60, v168, v192
    v_cvt_pk_bf16_f32 v61, v169, v193
    v_cvt_pk_bf16_f32 v62, v170, v194
    v_cvt_pk_bf16_f32 v63, v171, v195
    v_cvt_pk_bf16_f32 v64, v172, v196
    v_cvt_pk_bf16_f32 v65, v173, v197
    v_cvt_pk_bf16_f32 v66, v174, v198
    v_cvt_pk_bf16_f32 v67, v175, v199
    s_waitcnt lgkmcnt(0)
    v_mfma_f32_16x16x32_bf16 v[48:51], v[220:223], v[40:43], 0
    v_mfma_f32_16x16x32_bf16 v[100:103], v[236:239], v[40:43], 0
    v_mfma_f32_16x16x32_bf16 v[48:51], v[224:227], v[44:47], v[48:51]
    v_mfma_f32_16x16x32_bf16 v[100:103], v[240:243], v[44:47], v[100:103]
    v_mfma_f32_16x16x32_bf16 v[52:55], v[228:231], v[40:43], 0
    v_mfma_f32_16x16x32_bf16 v[104:107], v[244:247], v[40:43], 0
    v_mfma_f32_16x16x32_bf16 v[52:55], v[232:235], v[44:47], v[52:55]
    v_mfma_f32_16x16x32_bf16 v[104:107], v[248:251], v[44:47], v[104:107]
    v_mfma_f32_16x16x32_bf16 v[68:71], v[220:223], v[60:63], 0
    v_mfma_f32_16x16x32_bf16 v[120:123], v[236:239], v[60:63], 0
    v_mfma_f32_16x16x32_bf16 v[68:71], v[224:227], v[64:67], v[68:71]
    v_mfma_f32_16x16x32_bf16 v[120:123], v[240:243], v[64:67], v[120:123]
    v_mfma_f32_16x16x32_bf16 v[72:75], v[228:231], v[60:63], 0
    v_mfma_f32_16x16x32_bf16 v[124:127], v[244:247], v[60:63], 0
    v_mfma_f32_16x16x32_bf16 v[72:75], v[232:235], v[64:67], v[72:75]
    v_mfma_f32_16x16x32_bf16 v[124:127], v[248:251], v[64:67], v[124:127]
    s_cmp_eq_u32 s55, 0
    s_cbranch_scc1 A_S1_NOT3
    v_cvt_pk_bf16_f32 v80, v176, v200
    v_cvt_pk_bf16_f32 v81, v177, v201
    v_cvt_pk_bf16_f32 v82, v178, v202
    v_cvt_pk_bf16_f32 v83, v179, v203
    v_cvt_pk_bf16_f32 v84, v180, v204
    v_cvt_pk_bf16_f32 v85, v181, v205
    v_cvt_pk_bf16_f32 v86, v182, v206
    v_cvt_pk_bf16_f32 v87, v183, v207
    v_add_u32 v4, 512, v252
    s_branch A_S1_DO3
A_S1_NOT3:
    s_cmp_eq_u32 s4, 2
    s_cbranch_scc0 A_S1_NO3
    v_lshlrev_b32 v2, 4, v7
    ds_read_b128 v[88:91], v2 offset:43904
    ds_read_b128 v[92:95], v2 offset:43968
    v_add_u32 v4, 1024, v252
    v_cmp_gt_u32 vcc, 4, v6
    v_mov_b32 v3, 0x7fffffff
    s_nop 0
    v_cndmask_b32 v4, v3, v4, vcc
    s_waitcnt lgkmcnt(0)
    v_cvt_pk_bf16_f32 v80, v88, 0
    v_cvt_pk_bf16_f32 v81, v89, 0
    v_cvt_pk_bf16_f32 v82, v90, 0
    v_cvt_pk_bf16_f32 v83, v91, 0
    v_cvt_pk_bf16_f32 v84, v92, 0
    v_cvt_pk_bf16_f32 v85, v93, 0
    v_cvt_pk_bf16_f32 v86, v94, 0
    v_cvt_pk_bf16_f32 v87, v95, 0
A_S1_DO3:
    s_nop 2
    v_mfma_f32_16x16x32_bf16 v[88:91], v[220:223], v[80:83], 0
    v_mfma_f32_16x16x32_bf16 v[140:143], v[236:239], v[80:83], 0
    v_mfma_f32_16x16x32_bf16 v[88:91], v[224:227], v[84:87], v[88:91]
    v_mfma_f32_16x16x32_bf16 v[140:143], v[240:243], v[84:87], v[140:143]
    v_mfma_f32_16x16x32_bf16 v[92:95], v[228:231], v[80:83], 0
    v_mfma_f32_16x16x32_bf16 v[144:147], v[244:247], v[80:83], 0
    v_mfma_f32_16x16x32_bf16 v[92:95], v[232:235], v[84:87], v[92:95]
    v_mfma_f32_16x16x32_bf16 v[144:147], v[248:251], v[84:87], v[144:147]
    s_nop 3
    v_cvt_pk_bf16_f32 v148, v88, v140
    v_cvt_pk_bf16_f32 v149, v89, v141
    v_cvt_pk_bf16_f32 v150, v90, v142
    v_cvt_pk_bf16_f32 v151, v91, v143
    buffer_store_dwordx4 v[148:151], v4, s[40:43], 0 offen offset:0 sc1
    v_cvt_pk_bf16_f32 v152, v92, v144
    v_cvt_pk_bf16_f32 v153, v93, v145
    v_cvt_pk_bf16_f32 v154, v94, v146
    v_cvt_pk_bf16_f32 v155, v95, v147
    buffer_store_dwordx4 v[152:155], v4, s[40:43], s7 offen offset:0 sc1
A_S1_NO3:
    s_nop 7
    v_cvt_pk_bf16_f32 v108, v48, v100
    v_cvt_pk_bf16_f32 v109, v49, v101
    v_cvt_pk_bf16_f32 v110, v50, v102
    v_cvt_pk_bf16_f32 v111, v51, v103
    buffer_store_dwordx4 v[108:111], v252, s[40:43], 0 offen offset:0 sc1
    v_cvt_pk_bf16_f32 v112, v52, v104
    v_cvt_pk_bf16_f32 v113, v53, v105
    v_cvt_pk_bf16_f32 v114, v54, v106
    v_cvt_pk_bf16_f32 v115, v55, v107
    buffer_store_dwordx4 v[112:115], v252, s[40:43], s7 offen offset:0 sc1
    v_cvt_pk_bf16_f32 v128, v68, v120
    v_cvt_pk_bf16_f32 v129, v69, v121
    v_cvt_pk_bf16_f32 v130, v70, v122
    v_cvt_pk_bf16_f32 v131, v71, v123
    buffer_store_dwordx4 v[128:131], v252, s[40:43], 0 offen offset:256 sc1
    v_cvt_pk_bf16_f32 v132, v72, v124
    v_cvt_pk_bf16_f32 v133, v73, v125
    v_cvt_pk_bf16_f32 v134, v74, v126
    v_cvt_pk_bf16_f32 v135, v75, v127
    buffer_store_dwordx4 v[132:135], v252, s[40:43], s7 offen offset:256 sc1
    v_and_b32 v1, 63, v0
    v_mov_b32 v8, 159744
    v_mov_b32 v2, 0
    v_mov_b32 v3, 0
    ds_write_b64 v8, v[2:3]
    s_mov_b32 s14, 0
    s_mov_b32 s60, s32
    s_mov_b32 s61, s33
    s_mov_b32 s62, 256
    s_mov_b32 s63, 0x00020000
    s_lshl_b32 s13, s2, 2
    s_waitcnt vmcnt(0) lgkmcnt(0)
    s_barrier
    s_cmp_eq_u32 s4, 6
    s_cbranch_scc0 M_NOSIG
    s_or_b32 s15, s14, 1
    v_mov_b32 v2, s15
    v_lshlrev_b32 v3, 8, v1
    s_mov_b64 exec, 1
    buffer_store_dword v2, v3, s[60:63], s13 offen sc1
    s_mov_b64 exec, -1
M_NOSIG:
    v_and_b32 v5, 15, v1
    v_lshrrev_b32 v6, 4, v1
    s_lshr_b32 s6, s2, 3
    s_lshl_b32 s10, s4, 1
    s_add_u32 s11, s10, 1
    s_add_u32 s5, s4, 2
    s_cmp_lt_u32 s4, 2
    s_cselect_b32 s10, s10, s5
    s_cselect_b32 s11, s11, 10
    s_cselect_b32 s52, 1, 0
    s_lshl_b32 s5, s6, 3
    s_add_u32 s5, s5, s4
    s_cmp_eq_u32 s5, 58
    s_cselect_b32 s52, 1, s52
    s_lshl_b32 s12, s4, 12
    s_add_u32 s53, s12, 32768
    s_add_u32 s36, s34, 8388608
    s_addc_u32 s37, s35, 0
    s_mov_b32 s38, 2686976
    s_mov_b32 s39, 0x00020000
    s_add_u32 s40, s34, 12582912
    s_addc_u32 s41, s35, 0
    s_mov_b32 s42, 2686976
    s_mov_b32 s43, 0x00020000
    s_mul_i32 s6, s6, 320
    s_and_b32 s5, s2, 7
    s_mul_i32 s5, s5, 5248
    s_add_u32 s6, s6, s5
    v_lshrrev_b32 v2, 2, v1
    v_mul_u32_u24 v3, 41984, v2
    v_and_b32 v2, 3, v1
    v_lshl_add_u32 v3, v2, 4, v3
    v_lshlrev_b32 v2, 8, v6
    v_lshl_add_u32 v2, v5, 2, v2
    s_lshr_b32 s5, s10, 1
    s_lshl_b32 s5, s5, 6
    s_and_b32 s7, s10, 1
    s_mul_i32 s7, s7, 2624
    s_add_u32 s5, s5, s7
    s_add_u32 s5, s5, s6
    v_add_u32 v7, s5, v3
    v_add_u32 v9, s12, v2
    v_lshl_add_u32 v11, v1, 4, s12
    s_lshr_b32 s5, s11, 1
    s_lshl_b32 s5, s5, 6
    s_and_b32 s7, s11, 1
    s_mul_i32 s7, s7, 2624
    s_add_u32 s5, s5, s7
    s_add_u32 s5, s5, s6
    v_add_u32 v13, s5, v3
    v_add_u32 v10, s53, v2
    v_lshl_add_u32 v12, v1, 4, s53
    v_and_b32 v84, 3, v5
    v_lshl_add_u32 v4, v6, 4, v84
    v_lshlrev_b32 v4, 7, v4
    v_add_u32 v4, 45056, v4
    s_and_b32 s7, s2, 1
    s_lshl_b32 s7, s7, 3
    s_lshr_b32 s5, s10, 1
    s_lshl_b32 s5, s5, 4
    s_add_u32 s5, s5, s7
    s_and_b32 s6, s10, 1
    s_lshl_b32 s6, s6, 1
    s_add_u32 s5, s5, s6
    v_lshlrev_b32 v2, 1, v84
    v_and_b32 v3, 12, v5
    v_add3_u32 v2, v2, v3, s5
    v_lshlrev_b32 v3, 4, v84
    v_xor_b32 v3, v2, v3
    v_add_u32 v80, v3, v4
    v_xor_b32 v3, 64, v3
    v_add_u32 v81, v3, v4
    s_lshr_b32 s5, s11, 1
    s_lshl_b32 s5, s5, 4
    s_add_u32 s5, s5, s7
    s_and_b32 s6, s11, 1
    s_lshl_b32 s6, s6, 1
    s_add_u32 s5, s5, s6
    v_lshlrev_b32 v2, 1, v84
    v_and_b32 v3, 12, v5
    v_add3_u32 v2, v2, v3, s5
    v_lshlrev_b32 v3, 4, v84
    v_xor_b32 v3, v2, v3
    v_add_u32 v82, v3, v4
    v_xor_b32 v3, 64, v3
    v_add_u32 v83, v3, v4
    v_lshlrev_b32 v2, 2, v6
    v_cvt_f32_u32 v2, v2
    v_and_b32 v84, 1, v5
    v_mul_u32_u24 v84, 0x8000, v84
    v_lshl_or_b32 v84, v84, 16, v84
    v_lshlrev_b32 v2, 4, v1
    v_add_u32 v2, 110592, v2
    ds_read_b128 v[120:123], v2 offset:0
    ds_read_b128 v[152:155], v2 offset:1024
    ds_read_b128 v[128:131], v2 offset:2048
    ds_read_b128 v[160:163], v2 offset:3072
    ds_read_b128 v[136:139], v2 offset:4096
    ds_read_b128 v[168:171], v2 offset:5120
    ds_read_b128 v[144:147], v2 offset:6144
    ds_read_b128 v[176:179], v2 offset:7168
    s_waitcnt lgkmcnt(0)
    v_xor_b32 v124, v84, v120
    v_xor_b32 v156, v84, v152
    v_xor_b32 v125, v84, v121
    v_xor_b32 v157, v84, v153
    v_xor_b32 v126, v84, v122
    v_xor_b32 v158, v84, v154
    v_xor_b32 v127, v84, v123
    v_xor_b32 v159, v84, v155
    v_xor_b32 v132, v84, v128
    v_xor_b32 v164, v84, v160
    v_xor_b32 v133, v84, v129
    v_xor_b32 v165, v84, v161
    v_xor_b32 v134, v84, v130
    v_xor_b32 v166, v84, v162
    v_xor_b32 v135, v84, v131
    v_xor_b32 v167, v84, v163
    v_xor_b32 v140, v84, v136
    v_xor_b32 v172, v84, v168
    v_xor_b32 v141, v84, v137
    v_xor_b32 v173, v84, v169
    v_xor_b32 v142, v84, v138
    v_xor_b32 v174, v84, v170
    v_xor_b32 v143, v84, v139
    v_xor_b32 v175, v84, v171
    v_xor_b32 v148, v84, v144
    v_xor_b32 v180, v84, v176
    v_xor_b32 v149, v84, v145
    v_xor_b32 v181, v84, v177
    v_xor_b32 v150, v84, v146
    v_xor_b32 v182, v84, v178
    v_xor_b32 v151, v84, v147
    v_xor_b32 v183, v84, v179
    v_mov_b32 v16, 0
    v_mov_b32 v17, 0
    v_mov_b32 v18, 0
    v_mov_b32 v19, 0
    v_mov_b32 v20, 0
    v_mov_b32 v21, 0
    v_mov_b32 v22, 0
    v_mov_b32 v23, 0
    v_mov_b32 v24, 0
    v_mov_b32 v25, 0
    v_mov_b32 v26, 0
    v_mov_b32 v27, 0
    v_mov_b32 v28, 0
    v_mov_b32 v29, 0
    v_mov_b32 v30, 0
    v_mov_b32 v31, 0
    v_mov_b32 v32, 0
    v_mov_b32 v33, 0
    v_mov_b32 v34, 0
    v_mov_b32 v35, 0
    v_mov_b32 v36, 0
    v_mov_b32 v37, 0
    v_mov_b32 v38, 0
    v_mov_b32 v39, 0
    v_mov_b32 v40, 0
    v_mov_b32 v41, 0
    v_mov_b32 v42, 0
    v_mov_b32 v43, 0
    v_mov_b32 v44, 0
    v_mov_b32 v45, 0
    v_mov_b32 v46, 0
    v_mov_b32 v47, 0
    ds_read_u16_d16_hi v16, v80 offset:0
    ds_read_u16_d16_hi v17, v81 offset:512
    ds_read_u16_d16_hi v18, v80 offset:1024
    ds_read_u16_d16_hi v19, v81 offset:1536
    ds_read_u16_d16_hi v20, v80 offset:8192
    ds_read_u16_d16_hi v21, v81 offset:8704
    ds_read_u16_d16_hi v22, v80 offset:9216
    ds_read_u16_d16_hi v23, v81 offset:9728
    ds_read_u16_d16_hi v24, v80 offset:16384
    ds_read_u16_d16_hi v25, v81 offset:16896
    ds_read_u16_d16_hi v26, v80 offset:17408
    ds_read_u16_d16_hi v27, v81 offset:17920
    ds_read_u16_d16_hi v28, v80 offset:24576
    ds_read_u16_d16_hi v29, v81 offset:25088
    ds_read_u16_d16_hi v30, v80 offset:25600
    ds_read_u16_d16_hi v31, v81 offset:26112
    ds_read_u16_d16_hi v32, v80 offset:32768
    ds_read_u16_d16_hi v33, v81 offset:33280
    ds_read_u16_d16_hi v34, v80 offset:33792
    ds_read_u16_d16_hi v35, v81 offset:34304
    ds_read_u16_d16_hi v36, v80 offset:40960
    ds_read_u16_d16_hi v37, v81 offset:41472
    ds_read_u16_d16_hi v38, v80 offset:41984
    ds_read_u16_d16_hi v39, v81 offset:42496
    ds_read_u16_d16_hi v40, v80 offset:49152
    ds_read_u16_d16_hi v41, v81 offset:49664
    ds_read_u16_d16_hi v42, v80 offset:50176
    ds_read_u16_d16_hi v43, v81 offset:50688
    ds_read_u16_d16_hi v44, v80 offset:57344
    ds_read_u16_d16_hi v45, v81 offset:57856
    ds_read_u16_d16_hi v46, v80 offset:58368
    ds_read_u16_d16_hi v47, v81 offset:58880
    s_cmp_eq_u32 s52, 0
    s_cbranch_scc1 M_OPT1
    v_mov_b32 v48, 0
    v_mov_b32 v49, 0
    v_mov_b32 v50, 0
    v_mov_b32 v51, 0
    v_mov_b32 v52, 0
    v_mov_b32 v53, 0
    v_mov_b32 v54, 0
    v_mov_b32 v55, 0
    v_mov_b32 v56, 0
    v_mov_b32 v57, 0
    v_mov_b32 v58, 0
    v_mov_b32 v59, 0
    v_mov_b32 v60, 0
    v_mov_b32 v61, 0
    v_mov_b32 v62, 0
    v_mov_b32 v63, 0
    v_mov_b32 v64, 0
    v_mov_b32 v65, 0
    v_mov_b32 v66, 0
    v_mov_b32 v67, 0
    v_mov_b32 v68, 0
    v_mov_b32 v69, 0
    v_mov_b32 v70, 0
    v_mov_b32 v71, 0
    v_mov_b32 v72, 0
    v_mov_b32 v73, 0
    v_mov_b32 v74, 0
    v_mov_b32 v75, 0
    v_mov_b32 v76, 0
    v_mov_b32 v77, 0
    v_mov_b32 v78, 0
    v_mov_b32 v79, 0
    ds_read_u16_d16_hi v48, v82 offset:0
    ds_read_u16_d16_hi v49, v83 offset:512
    ds_read_u16_d16_hi v50, v82 offset:1024
    ds_read_u16_d16_hi v51, v83 offset:1536
    ds_read_u16_d16_hi v52, v82 offset:8192
    ds_read_u16_d16_hi v53, v83 offset:8704
    ds_read_u16_d16_hi v54, v82 offset:9216
    ds_read_u16_d16_hi v55, v83 offset:9728
    ds_read_u16_d16_hi v56, v82 offset:16384
    ds_read_u16_d16_hi v57, v83 offset:16896
    ds_read_u16_d16_hi v58, v82 offset:17408
    ds_read_u16_d16_hi v59, v83 offset:17920
    ds_read_u16_d16_hi v60, v82 offset:24576
    ds_read_u16_d16_hi v61, v83 offset:25088
    ds_read_u16_d16_hi v62, v82 offset:25600
    ds_read_u16_d16_hi v63, v83 offset:26112
    ds_read_u16_d16_hi v64, v82 offset:32768
    ds_read_u16_d16_hi v65, v83 offset:33280
    ds_read_u16_d16_hi v66, v82 offset:33792
    ds_read_u16_d16_hi v67, v83 offset:34304
    ds_read_u16_d16_hi v68, v82 offset:40960
    ds_read_u16_d16_hi v69, v83 offset:41472
    ds_read_u16_d16_hi v70, v82 offset:41984
    ds_read_u16_d16_hi v71, v83 offset:42496
    ds_read_u16_d16_hi v72, v82 offset:49152
    ds_read_u16_d16_hi v73, v83 offset:49664
    ds_read_u16_d16_hi v74, v82 offset:50176
    ds_read_u16_d16_hi v75, v83 offset:50688
    ds_read_u16_d16_hi v76, v82 offset:57344
    ds_read_u16_d16_hi v77, v83 offset:57856
    ds_read_u16_d16_hi v78, v82 offset:58368
    ds_read_u16_d16_hi v79, v83 offset:58880
M_OPT1:
    s_nop 7
    s_mov_b32 s54, 0
    s_mov_b32 s55, 671744
    s_mov_b32 s56, 1343488
    s_mov_b32 s57, 2015232
    s_cmp_eq_u32 s4, 3
    s_cbranch_scc0 M_SR
    s_and_b32 s6, s2, 31
    s_lshl_b32 s6, s6, 8
    s_mov_b32 s6, 0
    v_lshl_add_u32 v3, v1, 2, s6
    s_mov_b32 s5, 0
    s_or_b32 s15, s14, 1
M_POLL:
    buffer_load_dword v2, v3, s[60:63], 0 offen sc1
    s_waitcnt vmcnt(0)
    v_and_b32 v2, 4294967289, v2
    v_cmp_ne_u32 vcc, s15, v2
    s_add_u32 s5, s5, 1
    s_nop 4
    s_cbranch_vccz M_POLL_OK
    s_sleep 3
    s_cmp_lt_u32 s5, 200000
    s_cbranch_scc1 M_POLL
M_POLL_OK:
    s_mov_b64 exec, -1
    v_mov_b32 v2, 1
    ds_write_b32 v8, v2 offset:4
M_SR:
    ds_read_b32 v2, v8 offset:4
    s_waitcnt lgkmcnt(0)
    v_readfirstlane_b32 s5, v2
    s_nop 3
    s_cmp_ge_u32 s5, 1
    s_cbranch_scc1 M_SR_D
    s_sleep 1
    s_branch M_SR
M_SR_D:
    s_add_u32 m0, s12, 0
    s_nop 0
    buffer_load_dwordx4 v7, s[36:39], s54 offen sc1 lds
    s_add_u32 m0, s12, 1024
    s_nop 0
    buffer_load_dwordx4 v7, s[36:39], s55 offen sc1 lds
    s_add_u32 m0, s12, 2048
    s_nop 0
    buffer_load_dwordx4 v7, s[36:39], s56 offen sc1 lds
    s_add_u32 m0, s12, 3072
    s_nop 0
    buffer_load_dwordx4 v7, s[36:39], s57 offen sc1 lds
    s_cmp_eq_u32 s52, 0
    s_cbranch_scc1 M_OPT2
    s_add_u32 m0, s53, 0
    s_nop 0
    buffer_load_dwordx4 v13, s[36:39], s54 offen sc1 lds
    s_add_u32 m0, s53, 1024
    s_nop 0
    buffer_load_dwordx4 v13, s[36:39], s55 offen sc1 lds
    s_add_u32 m0, s53, 2048
    s_nop 0
    buffer_load_dwordx4 v13, s[36:39], s56 offen sc1 lds
    s_add_u32 m0, s53, 3072
    s_nop 0
    buffer_load_dwordx4 v13, s[36:39], s57 offen sc1 lds
M_OPT2:
    s_nop 7
    s_waitcnt vmcnt(0)
    ds_read_b32 v88, v9 offset:0
    ds_read_b32 v89, v9 offset:128
    ds_read_b32 v90, v9 offset:1024
    ds_read_b32 v91, v9 offset:1152
    ds_read_b32 v92, v9 offset:2048
    ds_read_b32 v93, v9 offset:2176
    ds_read_b32 v94, v9 offset:3072
    ds_read_b32 v95, v9 offset:3200
    ds_read_b32 v96, v9 offset:64
    ds_read_b32 v97, v9 offset:192
    ds_read_b32 v98, v9 offset:1088
    ds_read_b32 v99, v9 offset:1216
    ds_read_b32 v100, v9 offset:2112
    ds_read_b32 v101, v9 offset:2240
    ds_read_b32 v102, v9 offset:3136
    ds_read_b32 v103, v9 offset:3264
    s_cmp_eq_u32 s52, 0
    s_cbranch_scc1 M_OPT3
    ds_read_b32 v104, v10 offset:0
    ds_read_b32 v105, v10 offset:128
    ds_read_b32 v106, v10 offset:1024
    ds_read_b32 v107, v10 offset:1152
    ds_read_b32 v108, v10 offset:2048
    ds_read_b32 v109, v10 offset:2176
    ds_read_b32 v110, v10 offset:3072
    ds_read_b32 v111, v10 offset:3200
    ds_read_b32 v112, v10 offset:64
    ds_read_b32 v113, v10 offset:192
    ds_read_b32 v114, v10 offset:1088
    ds_read_b32 v115, v10 offset:1216
    ds_read_b32 v116, v10 offset:2112
    ds_read_b32 v117, v10 offset:2240
    ds_read_b32 v118, v10 offset:3136
    ds_read_b32 v119, v10 offset:3264
M_OPT3:
    s_nop 7
    s_waitcnt lgkmcnt(0)
    v_mfma_f32_16x16x32_bf16 v[184:187], v[120:123], v[88:91], 0
    v_mfma_f32_16x16x32_bf16 v[188:191], v[152:155], v[88:91], 0
    v_mfma_f32_16x16x32_bf16 v[192:195], v[136:139], v[88:91], 0
    v_mfma_f32_16x16x32_bf16 v[196:199], v[168:171], v[88:91], 0
    v_mfma_f32_16x16x32_bf16 v[200:203], v[128:131], v[96:99], 0
    v_mfma_f32_16x16x32_bf16 v[204:207], v[160:163], v[96:99], 0
    v_mfma_f32_16x16x32_bf16 v[208:211], v[144:147], v[96:99], 0
    v_mfma_f32_16x16x32_bf16 v[212:215], v[176:179], v[96:99], 0
    v_mfma_f32_16x16x32_bf16 v[184:187], v[124:127], v[92:95], v[184:187]
    v_mfma_f32_16x16x32_bf16 v[188:191], v[156:159], v[92:95], v[188:191]
    v_mfma_f32_16x16x32_bf16 v[192:195], v[140:143], v[92:95], v[192:195]
    v_mfma_f32_16x16x32_bf16 v[196:199], v[172:175], v[92:95], v[196:199]
    v_mfma_f32_16x16x32_bf16 v[200:203], v[132:135], v[100:103], v[200:203]
    v_mfma_f32_16x16x32_bf16 v[204:207], v[164:167], v[100:103], v[204:207]
    v_mfma_f32_16x16x32_bf16 v[208:211], v[148:151], v[100:103], v[208:211]
    v_mfma_f32_16x16x32_bf16 v[212:215], v[180:183], v[100:103], v[212:215]
    s_cmp_eq_u32 s52, 0
    s_cbranch_scc1 M_OPT4
    v_mfma_f32_16x16x32_bf16 v[216:219], v[120:123], v[104:107], 0
    v_mfma_f32_16x16x32_bf16 v[220:223], v[152:155], v[104:107], 0
    v_mfma_f32_16x16x32_bf16 v[224:227], v[136:139], v[104:107], 0
    v_mfma_f32_16x16x32_bf16 v[228:231], v[168:171], v[104:107], 0
    v_mfma_f32_16x16x32_bf16 v[232:235], v[128:131], v[112:115], 0
    v_mfma_f32_16x16x32_bf16 v[236:239], v[160:163], v[112:115], 0
    v_mfma_f32_16x16x32_bf16 v[240:243], v[144:147], v[112:115], 0
    v_mfma_f32_16x16x32_bf16 v[244:247], v[176:179], v[112:115], 0
    v_mfma_f32_16x16x32_bf16 v[216:219], v[124:127], v[108:111], v[216:219]
    v_mfma_f32_16x16x32_bf16 v[220:223], v[156:159], v[108:111], v[220:223]
    v_mfma_f32_16x16x32_bf16 v[224:227], v[140:143], v[108:111], v[224:227]
    v_mfma_f32_16x16x32_bf16 v[228:231], v[172:175], v[108:111], v[228:231]
    v_mfma_f32_16x16x32_bf16 v[232:235], v[132:135], v[116:119], v[232:235]
    v_mfma_f32_16x16x32_bf16 v[236:239], v[164:167], v[116:119], v[236:239]
    v_mfma_f32_16x16x32_bf16 v[240:243], v[148:151], v[116:119], v[240:243]
    v_mfma_f32_16x16x32_bf16 v[244:247], v[180:183], v[116:119], v[244:247]
M_OPT4:
    s_nop 7
    v_pk_add_f32 v[248:249], v[184:185], v[200:201]
    v_pk_add_f32 v[250:251], v[188:189], v[204:205]
    v_pk_add_f32 v[184:185], v[184:185], v[200:201] neg_lo:[0,1] neg_hi:[0,1]
    v_pk_add_f32 v[188:189], v[188:189], v[204:205] neg_lo:[0,1] neg_hi:[0,1]
    v_pk_mul_f32 v[200:201], v[248:249], v[16:17]
    v_pk_mul_f32 v[204:205], v[248:249], v[32:33]
    v_pk_fma_f32 v[200:201], v[250:251], v[32:33], v[200:201] neg_lo:[1,0,0] neg_hi:[1,0,0]
    v_pk_fma_f32 v[204:205], v[250:251], v[16:17], v[204:205]
    v_cvt_pk_bf16_f32 v88, v200, -v204
    v_cvt_pk_bf16_f32 v96, v201, -v205
    v_pk_mul_f32 v[252:253], v[184:185], v[24:25]
    v_pk_mul_f32 v[254:255], v[184:185], v[40:41]
    v_pk_fma_f32 v[252:253], v[188:189], v[40:41], v[252:253] neg_lo:[1,0,0] neg_hi:[1,0,0]
    v_pk_fma_f32 v[254:255], v[188:189], v[24:25], v[254:255]
    v_cvt_pk_bf16_f32 v92, v252, -v254
    v_cvt_pk_bf16_f32 v100, v253, -v255
    v_pk_add_f32 v[248:249], v[186:187], v[202:203]
    v_pk_add_f32 v[250:251], v[190:191], v[206:207]
    v_pk_add_f32 v[186:187], v[186:187], v[202:203] neg_lo:[0,1] neg_hi:[0,1]
    v_pk_add_f32 v[190:191], v[190:191], v[206:207] neg_lo:[0,1] neg_hi:[0,1]
    v_pk_mul_f32 v[202:203], v[248:249], v[18:19]
    v_pk_mul_f32 v[206:207], v[248:249], v[34:35]
    v_pk_fma_f32 v[202:203], v[250:251], v[34:35], v[202:203] neg_lo:[1,0,0] neg_hi:[1,0,0]
    v_pk_fma_f32 v[206:207], v[250:251], v[18:19], v[206:207]
    v_cvt_pk_bf16_f32 v89, v202, -v206
    v_cvt_pk_bf16_f32 v97, v203, -v207
    v_pk_mul_f32 v[252:253], v[186:187], v[26:27]
    v_pk_mul_f32 v[254:255], v[186:187], v[42:43]
    v_pk_fma_f32 v[252:253], v[190:191], v[42:43], v[252:253] neg_lo:[1,0,0] neg_hi:[1,0,0]
    v_pk_fma_f32 v[254:255], v[190:191], v[26:27], v[254:255]
    v_cvt_pk_bf16_f32 v93, v252, -v254
    v_cvt_pk_bf16_f32 v101, v253, -v255
    v_pk_add_f32 v[248:249], v[192:193], v[208:209]
    v_pk_add_f32 v[250:251], v[196:197], v[212:213]
    v_pk_add_f32 v[192:193], v[192:193], v[208:209] neg_lo:[0,1] neg_hi:[0,1]
    v_pk_add_f32 v[196:197], v[196:197], v[212:213] neg_lo:[0,1] neg_hi:[0,1]
    v_pk_mul_f32 v[208:209], v[248:249], v[20:21]
    v_pk_mul_f32 v[212:213], v[248:249], v[36:37]
    v_pk_fma_f32 v[208:209], v[250:251], v[36:37], v[208:209] neg_lo:[1,0,0] neg_hi:[1,0,0]
    v_pk_fma_f32 v[212:213], v[250:251], v[20:21], v[212:213]
    v_cvt_pk_bf16_f32 v90, v208, -v212
    v_cvt_pk_bf16_f32 v98, v209, -v213
    v_pk_mul_f32 v[252:253], v[192:193], v[28:29]
    v_pk_mul_f32 v[254:255], v[192:193], v[44:45]
    v_pk_fma_f32 v[252:253], v[196:197], v[44:45], v[252:253] neg_lo:[1,0,0] neg_hi:[1,0,0]
    v_pk_fma_f32 v[254:255], v[196:197], v[28:29], v[254:255]
    v_cvt_pk_bf16_f32 v94, v252, -v254
    v_cvt_pk_bf16_f32 v102, v253, -v255
    v_pk_add_f32 v[248:249], v[194:195], v[210:211]
    v_pk_add_f32 v[250:251], v[198:199], v[214:215]
    v_pk_add_f32 v[194:195], v[194:195], v[210:211] neg_lo:[0,1] neg_hi:[0,1]
    v_pk_add_f32 v[198:199], v[198:199], v[214:215] neg_lo:[0,1] neg_hi:[0,1]
    v_pk_mul_f32 v[210:211], v[248:249], v[22:23]
    v_pk_mul_f32 v[214:215], v[248:249], v[38:39]
    v_pk_fma_f32 v[210:211], v[250:251], v[38:39], v[210:211] neg_lo:[1,0,0] neg_hi:[1,0,0]
    v_pk_fma_f32 v[214:215], v[250:251], v[22:23], v[214:215]
    v_cvt_pk_bf16_f32 v91, v210, -v214
    v_cvt_pk_bf16_f32 v99, v211, -v215
    v_pk_mul_f32 v[252:253], v[194:195], v[30:31]
    v_pk_mul_f32 v[254:255], v[194:195], v[46:47]
    v_pk_fma_f32 v[252:253], v[198:199], v[46:47], v[252:253] neg_lo:[1,0,0] neg_hi:[1,0,0]
    v_pk_fma_f32 v[254:255], v[198:199], v[30:31], v[254:255]
    v_cvt_pk_bf16_f32 v95, v252, -v254
    v_cvt_pk_bf16_f32 v103, v253, -v255
    v_mfma_f32_16x16x32_bf16 v[184:187], v[120:123], v[88:91], 0
    v_mfma_f32_16x16x32_bf16 v[188:191], v[152:155], v[88:91], 0
    v_mfma_f32_16x16x32_bf16 v[192:195], v[136:139], v[88:91], 0
    v_mfma_f32_16x16x32_bf16 v[196:199], v[168:171], v[88:91], 0
    v_mfma_f32_16x16x32_bf16 v[200:203], v[128:131], v[96:99], 0
    v_mfma_f32_16x16x32_bf16 v[204:207], v[160:163], v[96:99], 0
    v_mfma_f32_16x16x32_bf16 v[208:211], v[144:147], v[96:99], 0
    v_mfma_f32_16x16x32_bf16 v[212:215], v[176:179], v[96:99], 0
    v_mfma_f32_16x16x32_bf16 v[184:187], v[124:127], v[92:95], v[184:187]
    v_mfma_f32_16x16x32_bf16 v[188:191], v[156:159], v[92:95], v[188:191]
    v_mfma_f32_16x16x32_bf16 v[192:195], v[140:143], v[92:95], v[192:195]
    v_mfma_f32_16x16x32_bf16 v[196:199], v[172:175], v[92:95], v[196:199]
    v_mfma_f32_16x16x32_bf16 v[200:203], v[132:135], v[100:103], v[200:203]
    v_mfma_f32_16x16x32_bf16 v[204:207], v[164:167], v[100:103], v[204:207]
    v_mfma_f32_16x16x32_bf16 v[208:211], v[148:151], v[100:103], v[208:211]
    v_mfma_f32_16x16x32_bf16 v[212:215], v[180:183], v[100:103], v[212:215]
    s_cmp_eq_u32 s52, 0
    s_cbranch_scc1 M_OPT5
    v_pk_add_f32 v[248:249], v[216:217], v[232:233]
    v_pk_add_f32 v[250:251], v[220:221], v[236:237]
    v_pk_add_f32 v[216:217], v[216:217], v[232:233] neg_lo:[0,1] neg_hi:[0,1]
    v_pk_add_f32 v[220:221], v[220:221], v[236:237] neg_lo:[0,1] neg_hi:[0,1]
    v_pk_mul_f32 v[232:233], v[248:249], v[48:49]
    v_pk_mul_f32 v[236:237], v[248:249], v[64:65]
    v_pk_fma_f32 v[232:233], v[250:251], v[64:65], v[232:233] neg_lo:[1,0,0] neg_hi:[1,0,0]
    v_pk_fma_f32 v[236:237], v[250:251], v[48:49], v[236:237]
    v_cvt_pk_bf16_f32 v104, v232, -v236
    v_cvt_pk_bf16_f32 v112, v233, -v237
    v_pk_mul_f32 v[252:253], v[216:217], v[56:57]
    v_pk_mul_f32 v[254:255], v[216:217], v[72:73]
    v_pk_fma_f32 v[252:253], v[220:221], v[72:73], v[252:253] neg_lo:[1,0,0] neg_hi:[1,0,0]
    v_pk_fma_f32 v[254:255], v[220:221], v[56:57], v[254:255]
    v_cvt_pk_bf16_f32 v108, v252, -v254
    v_cvt_pk_bf16_f32 v116, v253, -v255
    v_pk_add_f32 v[248:249], v[218:219], v[234:235]
    v_pk_add_f32 v[250:251], v[222:223], v[238:239]
    v_pk_add_f32 v[218:219], v[218:219], v[234:235] neg_lo:[0,1] neg_hi:[0,1]
    v_pk_add_f32 v[222:223], v[222:223], v[238:239] neg_lo:[0,1] neg_hi:[0,1]
    v_pk_mul_f32 v[234:235], v[248:249], v[50:51]
    v_pk_mul_f32 v[238:239], v[248:249], v[66:67]
    v_pk_fma_f32 v[234:235], v[250:251], v[66:67], v[234:235] neg_lo:[1,0,0] neg_hi:[1,0,0]
    v_pk_fma_f32 v[238:239], v[250:251], v[50:51], v[238:239]
    v_cvt_pk_bf16_f32 v105, v234, -v238
    v_cvt_pk_bf16_f32 v113, v235, -v239
    v_pk_mul_f32 v[252:253], v[218:219], v[58:59]
    v_pk_mul_f32 v[254:255], v[218:219], v[74:75]
    v_pk_fma_f32 v[252:253], v[222:223], v[74:75], v[252:253] neg_lo:[1,0,0] neg_hi:[1,0,0]
    v_pk_fma_f32 v[254:255], v[222:223], v[58:59], v[254:255]
    v_cvt_pk_bf16_f32 v109, v252, -v254
    v_cvt_pk_bf16_f32 v117, v253, -v255
    v_pk_add_f32 v[248:249], v[224:225], v[240:241]
    v_pk_add_f32 v[250:251], v[228:229], v[244:245]
    v_pk_add_f32 v[224:225], v[224:225], v[240:241] neg_lo:[0,1] neg_hi:[0,1]
    v_pk_add_f32 v[228:229], v[228:229], v[244:245] neg_lo:[0,1] neg_hi:[0,1]
    v_pk_mul_f32 v[240:241], v[248:249], v[52:53]
    v_pk_mul_f32 v[244:245], v[248:249], v[68:69]
    v_pk_fma_f32 v[240:241], v[250:251], v[68:69], v[240:241] neg_lo:[1,0,0] neg_hi:[1,0,0]
    v_pk_fma_f32 v[244:245], v[250:251], v[52:53], v[244:245]
    v_cvt_pk_bf16_f32 v106, v240, -v244
    v_cvt_pk_bf16_f32 v114, v241, -v245
    v_pk_mul_f32 v[252:253], v[224:225], v[60:61]
    v_pk_mul_f32 v[254:255], v[224:225], v[76:77]
    v_pk_fma_f32 v[252:253], v[228:229], v[76:77], v[252:253] neg_lo:[1,0,0] neg_hi:[1,0,0]
    v_pk_fma_f32 v[254:255], v[228:229], v[60:61], v[254:255]
    v_cvt_pk_bf16_f32 v110, v252, -v254
    v_cvt_pk_bf16_f32 v118, v253, -v255
    v_pk_add_f32 v[248:249], v[226:227], v[242:243]
    v_pk_add_f32 v[250:251], v[230:231], v[246:247]
    v_pk_add_f32 v[226:227], v[226:227], v[242:243] neg_lo:[0,1] neg_hi:[0,1]
    v_pk_add_f32 v[230:231], v[230:231], v[246:247] neg_lo:[0,1] neg_hi:[0,1]
    v_pk_mul_f32 v[242:243], v[248:249], v[54:55]
    v_pk_mul_f32 v[246:247], v[248:249], v[70:71]
    v_pk_fma_f32 v[242:243], v[250:251], v[70:71], v[242:243] neg_lo:[1,0,0] neg_hi:[1,0,0]
    v_pk_fma_f32 v[246:247], v[250:251], v[54:55], v[246:247]
    v_cvt_pk_bf16_f32 v107, v242, -v246
    v_cvt_pk_bf16_f32 v115, v243, -v247
    v_pk_mul_f32 v[252:253], v[226:227], v[62:63]
    v_pk_mul_f32 v[254:255], v[226:227], v[78:79]
    v_pk_fma_f32 v[252:253], v[230:231], v[78:79], v[252:253] neg_lo:[1,0,0] neg_hi:[1,0,0]
    v_pk_fma_f32 v[254:255], v[230:231], v[62:63], v[254:255]
    v_cvt_pk_bf16_f32 v111, v252, -v254
    v_cvt_pk_bf16_f32 v119, v253, -v255
    v_mfma_f32_16x16x32_bf16 v[216:219], v[120:123], v[104:107], 0
    v_mfma_f32_16x16x32_bf16 v[220:223], v[152:155], v[104:107], 0
    v_mfma_f32_16x16x32_bf16 v[224:227], v[136:139], v[104:107], 0
    v_mfma_f32_16x16x32_bf16 v[228:231], v[168:171], v[104:107], 0
    v_mfma_f32_16x16x32_bf16 v[232:235], v[128:131], v[112:115], 0
    v_mfma_f32_16x16x32_bf16 v[236:239], v[160:163], v[112:115], 0
    v_mfma_f32_16x16x32_bf16 v[240:243], v[144:147], v[112:115], 0
    v_mfma_f32_16x16x32_bf16 v[244:247], v[176:179], v[112:115], 0
    v_mfma_f32_16x16x32_bf16 v[216:219], v[124:127], v[108:111], v[216:219]
    v_mfma_f32_16x16x32_bf16 v[220:223], v[156:159], v[108:111], v[220:223]
    v_mfma_f32_16x16x32_bf16 v[224:227], v[140:143], v[108:111], v[224:227]
    v_mfma_f32_16x16x32_bf16 v[228:231], v[172:175], v[108:111], v[228:231]
    v_mfma_f32_16x16x32_bf16 v[232:235], v[132:135], v[116:119], v[232:235]
    v_mfma_f32_16x16x32_bf16 v[236:239], v[164:167], v[116:119], v[236:239]
    v_mfma_f32_16x16x32_bf16 v[240:243], v[148:151], v[116:119], v[240:243]
    v_mfma_f32_16x16x32_bf16 v[244:247], v[180:183], v[116:119], v[244:247]
M_OPT5:
    s_nop 7
    v_pk_add_f32 v[248:249], v[184:185], v[200:201]
    v_pk_add_f32 v[250:251], v[188:189], v[204:205]
    v_pk_add_f32 v[184:185], v[184:185], v[200:201] neg_lo:[0,1] neg_hi:[0,1]
    v_pk_add_f32 v[188:189], v[188:189], v[204:205] neg_lo:[0,1] neg_hi:[0,1]
    v_cvt_pk_bf16_f32 v200, v248, -v250
    ds_write_b32 v9, v200 offset:0
    v_cvt_pk_bf16_f32 v201, v249, -v251
    ds_write_b32 v9, v201 offset:64
    v_cvt_pk_bf16_f32 v204, v184, -v188
    ds_write_b32 v9, v204 offset:2048
    v_cvt_pk_bf16_f32 v205, v185, -v189
    ds_write_b32 v9, v205 offset:2112
    v_pk_add_f32 v[248:249], v[186:187], v[202:203]
    v_pk_add_f32 v[250:251], v[190:191], v[206:207]
    v_pk_add_f32 v[186:187], v[186:187], v[202:203] neg_lo:[0,1] neg_hi:[0,1]
    v_pk_add_f32 v[190:191], v[190:191], v[206:207] neg_lo:[0,1] neg_hi:[0,1]
    v_cvt_pk_bf16_f32 v202, v248, -v250
    ds_write_b32 v9, v202 offset:128
    v_cvt_pk_bf16_f32 v203, v249, -v251
    ds_write_b32 v9, v203 offset:192
    v_cvt_pk_bf16_f32 v206, v186, -v190
    ds_write_b32 v9, v206 offset:2176
    v_cvt_pk_bf16_f32 v207, v187, -v191
    ds_write_b32 v9, v207 offset:2240
    v_pk_add_f32 v[248:249], v[192:193], v[208:209]
    v_pk_add_f32 v[250:251], v[196:197], v[212:213]
    v_pk_add_f32 v[192:193], v[192:193], v[208:209] neg_lo:[0,1] neg_hi:[0,1]
    v_pk_add_f32 v[196:197], v[196:197], v[212:213] neg_lo:[0,1] neg_hi:[0,1]
    v_cvt_pk_bf16_f32 v208, v248, -v250
    ds_write_b32 v9, v208 offset:1024
    v_cvt_pk_bf16_f32 v209, v249, -v251
    ds_write_b32 v9, v209 offset:1088
    v_cvt_pk_bf16_f32 v212, v192, -v196
    ds_write_b32 v9, v212 offset:3072
    v_cvt_pk_bf16_f32 v213, v193, -v197
    ds_write_b32 v9, v213 offset:3136
    v_pk_add_f32 v[248:249], v[194:195], v[210:211]
    v_pk_add_f32 v[250:251], v[198:199], v[214:215]
    v_pk_add_f32 v[194:195], v[194:195], v[210:211] neg_lo:[0,1] neg_hi:[0,1]
    v_pk_add_f32 v[198:199], v[198:199], v[214:215] neg_lo:[0,1] neg_hi:[0,1]
    v_cvt_pk_bf16_f32 v210, v248, -v250
    ds_write_b32 v9, v210 offset:1152
    v_cvt_pk_bf16_f32 v211, v249, -v251
    ds_write_b32 v9, v211 offset:1216
    v_cvt_pk_bf16_f32 v214, v194, -v198
    ds_write_b32 v9, v214 offset:3200
    v_cvt_pk_bf16_f32 v215, v195, -v199
    ds_write_b32 v9, v215 offset:3264
    s_waitcnt lgkmcnt(0)
    ds_read_b128 v[88:91], v11 offset:0
    ds_read_b128 v[92:95], v11 offset:1024
    ds_read_b128 v[96:99], v11 offset:2048
    ds_read_b128 v[100:103], v11 offset:3072
    s_waitcnt lgkmcnt(3)
    buffer_store_dwordx4 v[88:91], v7, s[40:43], s54 offen sc1
    s_waitcnt lgkmcnt(2)
    buffer_store_dwordx4 v[92:95], v7, s[40:43], s55 offen sc1
    s_waitcnt lgkmcnt(1)
    buffer_store_dwordx4 v[96:99], v7, s[40:43], s56 offen sc1
    s_waitcnt lgkmcnt(0)
    buffer_store_dwordx4 v[100:103], v7, s[40:43], s57 offen sc1
    s_cmp_eq_u32 s52, 0
    s_cbranch_scc1 M_OPT6
    v_pk_add_f32 v[248:249], v[216:217], v[232:233]
    v_pk_add_f32 v[250:251], v[220:221], v[236:237]
    v_pk_add_f32 v[216:217], v[216:217], v[232:233] neg_lo:[0,1] neg_hi:[0,1]
    v_pk_add_f32 v[220:221], v[220:221], v[236:237] neg_lo:[0,1] neg_hi:[0,1]
    v_cvt_pk_bf16_f32 v232, v248, -v250
    ds_write_b32 v10, v232 offset:0
    v_cvt_pk_bf16_f32 v233, v249, -v251
    ds_write_b32 v10, v233 offset:64
    v_cvt_pk_bf16_f32 v236, v216, -v220
    ds_write_b32 v10, v236 offset:2048
    v_cvt_pk_bf16_f32 v237, v217, -v221
    ds_write_b32 v10, v237 offset:2112
    v_pk_add_f32 v[248:249], v[218:219], v[234:235]
    v_pk_add_f32 v[250:251], v[222:223], v[238:239]
    v_pk_add_f32 v[218:219], v[218:219], v[234:235] neg_lo:[0,1] neg_hi:[0,1]
    v_pk_add_f32 v[222:223], v[222:223], v[238:239] neg_lo:[0,1] neg_hi:[0,1]
    v_cvt_pk_bf16_f32 v234, v248, -v250
    ds_write_b32 v10, v234 offset:128
    v_cvt_pk_bf16_f32 v235, v249, -v251
    ds_write_b32 v10, v235 offset:192
    v_cvt_pk_bf16_f32 v238, v218, -v222
    ds_write_b32 v10, v238 offset:2176
    v_cvt_pk_bf16_f32 v239, v219, -v223
    ds_write_b32 v10, v239 offset:2240
    v_pk_add_f32 v[248:249], v[224:225], v[240:241]
    v_pk_add_f32 v[250:251], v[228:229], v[244:245]
    v_pk_add_f32 v[224:225], v[224:225], v[240:241] neg_lo:[0,1] neg_hi:[0,1]
    v_pk_add_f32 v[228:229], v[228:229], v[244:245] neg_lo:[0,1] neg_hi:[0,1]
    v_cvt_pk_bf16_f32 v240, v248, -v250
    ds_write_b32 v10, v240 offset:1024
    v_cvt_pk_bf16_f32 v241, v249, -v251
    ds_write_b32 v10, v241 offset:1088
    v_cvt_pk_bf16_f32 v244, v224, -v228
    ds_write_b32 v10, v244 offset:3072
    v_cvt_pk_bf16_f32 v245, v225, -v229
    ds_write_b32 v10, v245 offset:3136
    v_pk_add_f32 v[248:249], v[226:227], v[242:243]
    v_pk_add_f32 v[250:251], v[230:231], v[246:247]
    v_pk_add_f32 v[226:227], v[226:227], v[242:243] neg_lo:[0,1] neg_hi:[0,1]
    v_pk_add_f32 v[230:231], v[230:231], v[246:247] neg_lo:[0,1] neg_hi:[0,1]
    v_cvt_pk_bf16_f32 v242, v248, -v250
    ds_write_b32 v10, v242 offset:1152
    v_cvt_pk_bf16_f32 v243, v249, -v251
    ds_write_b32 v10, v243 offset:1216
    v_cvt_pk_bf16_f32 v246, v226, -v230
    ds_write_b32 v10, v246 offset:3200
    v_cvt_pk_bf16_f32 v247, v227, -v231
    ds_write_b32 v10, v247 offset:3264
    s_waitcnt lgkmcnt(0)
    ds_read_b128 v[104:107], v12 offset:0
    ds_read_b128 v[108:111], v12 offset:1024
    ds_read_b128 v[112:115], v12 offset:2048
    ds_read_b128 v[116:119], v12 offset:3072
    s_waitcnt lgkmcnt(3)
    buffer_store_dwordx4 v[104:107], v13, s[40:43], s54 offen sc1
    s_waitcnt lgkmcnt(2)
    buffer_store_dwordx4 v[108:111], v13, s[40:43], s55 offen sc1
    s_waitcnt lgkmcnt(1)
    buffer_store_dwordx4 v[112:115], v13, s[40:43], s56 offen sc1
    s_waitcnt lgkmcnt(0)
    buffer_store_dwordx4 v[116:119], v13, s[40:43], s57 offen sc1
M_OPT6:
    s_nop 7
    s_endpgm
K1_END:
    s_endpgm
.globl k2_kernel
.p2align 8
.type k2_kernel,@function
k2_kernel:
    s_cmp_ge_u32 s2, 256
    s_cbranch_scc1 K2_END
    s_load_dwordx16 s[16:31], s[0:1], 0
    s_load_dwordx4 s[32:35], s[0:1], 64
    v_lshrrev_b32 v1, 6, v0
    s_nop 0
    v_readfirstlane_b32 s4, v1
    s_waitcnt lgkmcnt(0)
    s_mov_b32 s36, s34
    s_mov_b32 s37, s35
    s_mov_b32 s38, 6422528
    s_mov_b32 s39, 0x00020000
    s_add_u32 s40, s34, 16777216
    s_addc_u32 s41, s35, 0
    s_mov_b32 s42, 1966080
    s_mov_b32 s43, 0x00020000
    s_add_u32 s44, s34, 12582912
    s_addc_u32 s45, s35, 0
    s_mov_b32 s46, 2686976
    s_mov_b32 s47, 0x00020000
    s_mov_b32 s48, s16
    s_mov_b32 s49, s17
    s_mov_b32 s50, 2621440
    s_mov_b32 s51, 0x00020000
    s_mov_b32 s60, s30
    s_mov_b32 s61, s31
    s_mov_b32 s62, 2621440
    s_mov_b32 s63, 0x00020000
    s_add_u32 s64, s34, 15728640
    s_addc_u32 s65, s35, 0
    s_mov_b32 s66, 32768
    s_mov_b32 s67, 0x00020000
    s_and_b32 s5, s2, 7
    s_lshr_b32 s6, s2, 3
    s_lshr_b32 s7, s5, 1
    s_lshl_b32 s7, s7, 3
    s_and_b32 s8, s6, 7
    s_add_u32 s52, s7, s8
    s_and_b32 s7, s5, 1
    s_lshl_b32 s7, s7, 2
    s_lshr_b32 s8, s6, 3
    s_add_u32 s53, s7, s8
    s_and_b32 s54, s4, 3
    v_and_b32 v1, 63, v0
    v_and_b32 v5, 15, v1
    v_lshrrev_b32 v6, 4, v1
    s_cmp_ge_u32 s4, 4
    s_cbranch_scc1 K2_AF
    s_mul_i32 s5, s52, 200704
    s_mul_i32 s6, s54, 12288
    s_add_u32 s56, s5, s6
    v_lshlrev_b32 v8, 4, v1
    s_mul_i32 s57, s54, 61440
    s_mul_i32 s5, s53, 245760
    s_add_u32 s57, s57, s5
    s_mul_i32 s55, s54, 30720
    s_mov_b32 s8, 6554
    s_mov_b32 s58, s56
    v_add_u32 v10, 0, v8
    v_add_u32 v11, 50176, v8
    v_add_u32 v12, 100352, v8
    v_add_u32 v13, 150528, v8
    s_add_u32 s8, s57, 0
    s_add_u32 s9, s57, 1024
    s_add_u32 s10, s57, 2048
    s_add_u32 s11, s57, 3072
    s_add_u32 s12, s57, 4096
    s_and_b32 s6, s2, 15
    s_lshl_b32 s6, s6, 10
    s_add_u32 s6, s6, 8192
    s_add_u32 m0, s55, 0
    s_nop 0
    buffer_load_dwordx4 v8, s[40:43], s8 offen lds
    s_add_u32 s8, s8, 5120
    s_add_u32 m0, s55, 1024
    s_nop 0
    buffer_load_dwordx4 v8, s[40:43], s9 offen lds
    s_add_u32 s9, s9, 5120
    s_add_u32 m0, s55, 2048
    s_nop 0
    buffer_load_dwordx4 v8, s[40:43], s10 offen lds
    s_add_u32 s10, s10, 5120
    s_add_u32 m0, s55, 3072
    s_nop 0
    buffer_load_dwordx4 v8, s[40:43], s11 offen lds
    s_add_u32 s11, s11, 5120
    s_add_u32 m0, s55, 4096
    s_nop 0
    buffer_load_dwordx4 v8, s[40:43], s12 offen lds
    s_add_u32 s12, s12, 5120
    buffer_load_dwordx4 v[96:99], v10, s[36:39], s58 offen
    s_add_u32 s58, s58, 1024
    buffer_load_dwordx4 v[100:103], v11, s[36:39], s56 offen
    buffer_load_dwordx4 v[104:107], v12, s[36:39], s56 offen
    buffer_load_dwordx4 v[108:111], v13, s[36:39], s56 offen
    s_add_u32 s56, s56, 1024
    s_add_u32 m0, s55, 5120
    s_nop 0
    buffer_load_dwordx4 v8, s[40:43], s8 offen lds
    s_add_u32 s8, s8, 5120
    s_add_u32 m0, s55, 6144
    s_nop 0
    buffer_load_dwordx4 v8, s[40:43], s9 offen lds
    s_add_u32 s9, s9, 5120
    s_add_u32 m0, s55, 7168
    s_nop 0
    buffer_load_dwordx4 v8, s[40:43], s10 offen lds
    s_add_u32 s10, s10, 5120
    s_add_u32 m0, s55, 8192
    s_nop 0
    buffer_load_dwordx4 v8, s[40:43], s11 offen lds
    s_add_u32 s11, s11, 5120
    s_add_u32 m0, s55, 9216
    s_nop 0
    buffer_load_dwordx4 v8, s[40:43], s12 offen lds
    s_add_u32 s12, s12, 5120
    buffer_load_dwordx4 v[112:115], v10, s[36:39], s58 offen
    s_add_u32 s58, s58, 1024
    buffer_load_dwordx4 v[116:119], v11, s[36:39], s56 offen
    buffer_load_dwordx4 v[120:123], v12, s[36:39], s56 offen
    buffer_load_dwordx4 v[124:127], v13, s[36:39], s56 offen
    s_add_u32 s56, s56, 1024
    v_add_u32 v9, s55, v8
    s_waitcnt vmcnt(13)
    ds_read_b128 v[192:195], v9 offset:0
    ds_read_b128 v[196:199], v9 offset:1024
    ds_read_b128 v[200:203], v9 offset:2048
    ds_read_b128 v[204:207], v9 offset:3072
    ds_read_b128 v[208:211], v9 offset:4096
    s_waitcnt vmcnt(4) lgkmcnt(0)
    v_mfma_f32_16x16x32_bf16 v[16:19], v[192:195], v[96:99], 0
    ds_read_b128 v[212:215], v9 offset:5120
    v_mfma_f32_16x16x32_bf16 v[20:23], v[196:199], v[96:99], 0
    ds_read_b128 v[216:219], v9 offset:6144
    v_mfma_f32_16x16x32_bf16 v[24:27], v[200:203], v[96:99], 0
    ds_read_b128 v[220:223], v9 offset:7168
    v_mfma_f32_16x16x32_bf16 v[28:31], v[204:207], v[96:99], 0
    ds_read_b128 v[224:227], v9 offset:8192
    v_mfma_f32_16x16x32_bf16 v[32:35], v[208:211], v[96:99], 0
    ds_read_b128 v[228:231], v9 offset:9216
    v_mfma_f32_16x16x32_bf16 v[36:39], v[192:195], v[100:103], 0
    s_add_u32 m0, s55, 10240
    s_nop 0
    buffer_load_dwordx4 v8, s[40:43], s8 offen lds
    s_add_u32 s8, s8, 5120
    v_mfma_f32_16x16x32_bf16 v[40:43], v[196:199], v[100:103], 0
    s_add_u32 m0, s55, 11264
    s_nop 0
    buffer_load_dwordx4 v8, s[40:43], s9 offen lds
    s_add_u32 s9, s9, 5120
    v_mfma_f32_16x16x32_bf16 v[44:47], v[200:203], v[100:103], 0
    s_add_u32 m0, s55, 12288
    s_nop 0
    buffer_load_dwordx4 v8, s[40:43], s10 offen lds
    s_add_u32 s10, s10, 5120
    v_mfma_f32_16x16x32_bf16 v[48:51], v[204:207], v[100:103], 0
    s_add_u32 m0, s55, 13312
    s_nop 0
    buffer_load_dwordx4 v8, s[40:43], s11 offen lds
    s_add_u32 s11, s11, 5120
    v_mfma_f32_16x16x32_bf16 v[52:55], v[208:211], v[100:103], 0
    s_add_u32 m0, s55, 14336
    s_nop 0
    buffer_load_dwordx4 v8, s[40:43], s12 offen lds
    s_add_u32 s12, s12, 5120
    v_mfma_f32_16x16x32_bf16 v[56:59], v[192:195], v[104:107], 0
    buffer_load_dwordx4 v[128:131], v10, s[36:39], s58 offen
    s_add_u32 s58, s58, 1024
    v_mfma_f32_16x16x32_bf16 v[60:63], v[196:199], v[104:107], 0
    buffer_load_dwordx4 v[132:135], v11, s[36:39], s56 offen
    v_mfma_f32_16x16x32_bf16 v[64:67], v[200:203], v[104:107], 0
    buffer_load_dwordx4 v[136:139], v12, s[36:39], s56 offen
    v_mfma_f32_16x16x32_bf16 v[68:71], v[204:207], v[104:107], 0
    buffer_load_dwordx4 v[140:143], v13, s[36:39], s56 offen
    s_add_u32 s56, s56, 1024
    v_mfma_f32_16x16x32_bf16 v[72:75], v[208:211], v[104:107], 0
    s_add_u32 m0, s55, 15360
    s_nop 0
    buffer_load_dwordx4 v8, s[40:43], s8 offen lds
    s_add_u32 s8, s8, 5120
    v_mfma_f32_16x16x32_bf16 v[76:79], v[192:195], v[108:111], 0
    s_add_u32 m0, s55, 16384
    s_nop 0
    buffer_load_dwordx4 v8, s[40:43], s9 offen lds
    s_add_u32 s9, s9, 5120
    v_mfma_f32_16x16x32_bf16 v[80:83], v[196:199], v[108:111], 0
    s_add_u32 m0, s55, 17408
    s_nop 0
    buffer_load_dwordx4 v8, s[40:43], s10 offen lds
    s_add_u32 s10, s10, 5120
    v_mfma_f32_16x16x32_bf16 v[84:87], v[200:203], v[108:111], 0
    s_add_u32 m0, s55, 18432
    s_nop 0
    buffer_load_dwordx4 v8, s[40:43], s11 offen lds
    s_add_u32 s11, s11, 5120
    v_mfma_f32_16x16x32_bf16 v[88:91], v[204:207], v[108:111], 0
    s_add_u32 m0, s55, 19456
    s_nop 0
    buffer_load_dwordx4 v8, s[40:43], s12 offen lds
    s_add_u32 s12, s12, 5120
    v_mfma_f32_16x16x32_bf16 v[92:95], v[208:211], v[108:111], 0
    buffer_load_dwordx4 v[144:147], v10, s[36:39], s58 offen
    s_add_u32 s58, s58, 1024
    s_waitcnt vmcnt(10) lgkmcnt(0)
    v_mfma_f32_16x16x32_bf16 v[16:19], v[212:215], v[112:115], v[16:19]
    ds_read_b128 v[192:195], v9 offset:10240
    v_mfma_f32_16x16x32_bf16 v[20:23], v[216:219], v[112:115], v[20:23]
    ds_read_b128 v[196:199], v9 offset:11264
    v_mfma_f32_16x16x32_bf16 v[24:27], v[220:223], v[112:115], v[24:27]
    ds_read_b128 v[200:203], v9 offset:12288
    v_mfma_f32_16x16x32_bf16 v[28:31], v[224:227], v[112:115], v[28:31]
    ds_read_b128 v[204:207], v9 offset:13312
    v_mfma_f32_16x16x32_bf16 v[32:35], v[228:231], v[112:115], v[32:35]
    ds_read_b128 v[208:211], v9 offset:14336
    v_mfma_f32_16x16x32_bf16 v[36:39], v[212:215], v[116:119], v[36:39]
    buffer_load_dwordx4 v[148:151], v11, s[36:39], s56 offen
    v_mfma_f32_16x16x32_bf16 v[40:43], v[216:219], v[116:119], v[40:43]
    buffer_load_dwordx4 v[152:155], v12, s[36:39], s56 offen
    v_mfma_f32_16x16x32_bf16 v[44:47], v[220:223], v[116:119], v[44:47]
    buffer_load_dwordx4 v[156:159], v13, s[36:39], s56 offen
    s_add_u32 s56, s56, 1024
    v_mfma_f32_16x16x32_bf16 v[48:51], v[224:227], v[116:119], v[48:51]
    s_add_u32 m0, s55, 20480
    s_nop 0
    buffer_load_dwordx4 v8, s[40:43], s8 offen lds
    s_add_u32 s8, s8, 5120
    v_mfma_f32_16x16x32_bf16 v[52:55], v[228:231], v[116:119], v[52:55]
    s_add_u32 m0, s55, 21504
    s_nop 0
    buffer_load_dwordx4 v8, s[40:43], s9 offen lds
    s_add_u32 s9, s9, 5120
    v_mfma_f32_16x16x32_bf16 v[56:59], v[212:215], v[120:123], v[56:59]
    s_add_u32 m0, s55, 22528
    s_nop 0
    buffer_load_dwordx4 v8, s[40:43], s10 offen lds
    s_add_u32 s10, s10, 5120
    v_mfma_f32_16x16x32_bf16 v[60:63], v[216:219], v[120:123], v[60:63]
    s_add_u32 m0, s55, 23552
    s_nop 0
    buffer_load_dwordx4 v8, s[40:43], s11 offen lds
    s_add_u32 s11, s11, 5120
    v_mfma_f32_16x16x32_bf16 v[64:67], v[220:223], v[120:123], v[64:67]
    s_add_u32 m0, s55, 24576
    s_nop 0
    buffer_load_dwordx4 v8, s[40:43], s12 offen lds
    s_add_u32 s12, s12, 5120
    v_mfma_f32_16x16x32_bf16 v[68:71], v[224:227], v[120:123], v[68:71]
    buffer_load_dwordx4 v[160:163], v10, s[36:39], s58 offen
    s_add_u32 s58, s58, 1024
    v_mfma_f32_16x16x32_bf16 v[72:75], v[228:231], v[120:123], v[72:75]
    buffer_load_dwordx4 v[164:167], v11, s[36:39], s56 offen
    v_mfma_f32_16x16x32_bf16 v[76:79], v[212:215], v[124:127], v[76:79]
    buffer_load_dwordx4 v[168:171], v12, s[36:39], s56 offen
    v_mfma_f32_16x16x32_bf16 v[80:83], v[216:219], v[124:127], v[80:83]
    buffer_load_dwordx4 v[172:175], v13, s[36:39], s56 offen
    s_add_u32 s56, s56, 1024
    v_mfma_f32_16x16x32_bf16 v[84:87], v[220:223], v[124:127], v[84:87]
    s_add_u32 m0, s55, 25600
    s_nop 0
    buffer_load_dwordx4 v8, s[40:43], s8 offen lds
    s_add_u32 s8, s8, 5120
    v_mfma_f32_16x16x32_bf16 v[88:91], v[224:227], v[124:127], v[88:91]
    s_add_u32 m0, s55, 26624
    s_nop 0
    buffer_load_dwordx4 v8, s[40:43], s9 offen lds
    s_add_u32 s9, s9, 5120
    v_mfma_f32_16x16x32_bf16 v[92:95], v[228:231], v[124:127], v[92:95]
    s_add_u32 m0, s55, 27648
    s_nop 0
    buffer_load_dwordx4 v8, s[40:43], s10 offen lds
    s_add_u32 s10, s10, 5120
    s_waitcnt vmcnt(16) lgkmcnt(0)
    v_mfma_f32_16x16x32_bf16 v[16:19], v[192:195], v[128:131], v[16:19]
    ds_read_b128 v[212:215], v9 offset:15360
    v_mfma_f32_16x16x32_bf16 v[20:23], v[196:199], v[128:131], v[20:23]
    ds_read_b128 v[216:219], v9 offset:16384
    v_mfma_f32_16x16x32_bf16 v[24:27], v[200:203], v[128:131], v[24:27]
    ds_read_b128 v[220:223], v9 offset:17408
    v_mfma_f32_16x16x32_bf16 v[28:31], v[204:207], v[128:131], v[28:31]
    ds_read_b128 v[224:227], v9 offset:18432
    v_mfma_f32_16x16x32_bf16 v[32:35], v[208:211], v[128:131], v[32:35]
    ds_read_b128 v[228:231], v9 offset:19456
    v_mfma_f32_16x16x32_bf16 v[36:39], v[192:195], v[132:135], v[36:39]
    s_add_u32 m0, s55, 28672
    s_nop 0
    buffer_load_dwordx4 v8, s[40:43], s11 offen lds
    s_add_u32 s11, s11, 5120
    v_mfma_f32_16x16x32_bf16 v[40:43], v[196:199], v[132:135], v[40:43]
    s_add_u32 m0, s55, 29696
    s_nop 0
    buffer_load_dwordx4 v8, s[40:43], s12 offen lds
    s_add_u32 s12, s12, 5120
    v_mfma_f32_16x16x32_bf16 v[44:47], v[200:203], v[132:135], v[44:47]
    buffer_load_dwordx4 v[176:179], v10, s[36:39], s58 offen
    s_add_u32 s58, s58, 1024
    v_mfma_f32_16x16x32_bf16 v[48:51], v[204:207], v[132:135], v[48:51]
    buffer_load_dwordx4 v[180:183], v11, s[36:39], s56 offen
    v_mfma_f32_16x16x32_bf16 v[52:55], v[208:211], v[132:135], v[52:55]
    buffer_load_dwordx4 v[184:187], v12, s[36:39], s56 offen
    v_mfma_f32_16x16x32_bf16 v[56:59], v[192:195], v[136:139], v[56:59]
    buffer_load_dwordx4 v[188:191], v13, s[36:39], s56 offen
    s_add_u32 s56, s56, 1024
    v_mfma_f32_16x16x32_bf16 v[60:63], v[196:199], v[136:139], v[60:63]
    s_add_u32 m0, s55, 0
    s_nop 0
    buffer_load_dwordx4 v8, s[40:43], s8 offen lds
    s_add_u32 s8, s8, 5120
    v_mfma_f32_16x16x32_bf16 v[64:67], v[200:203], v[136:139], v[64:67]
    s_add_u32 m0, s55, 1024
    s_nop 0
    buffer_load_dwordx4 v8, s[40:43], s9 offen lds
    s_add_u32 s9, s9, 5120
    v_mfma_f32_16x16x32_bf16 v[68:71], v[204:207], v[136:139], v[68:71]
    s_add_u32 m0, s55, 2048
    s_nop 0
    buffer_load_dwordx4 v8, s[40:43], s10 offen lds
    s_add_u32 s10, s10, 5120
    v_mfma_f32_16x16x32_bf16 v[72:75], v[208:211], v[136:139], v[72:75]
    s_add_u32 m0, s55, 3072
    s_nop 0
    buffer_load_dwordx4 v8, s[40:43], s11 offen lds
    s_add_u32 s11, s11, 5120
    v_mfma_f32_16x16x32_bf16 v[76:79], v[192:195], v[140:143], v[76:79]
    s_add_u32 m0, s55, 4096
    s_nop 0
    buffer_load_dwordx4 v8, s[40:43], s12 offen lds
    s_add_u32 s12, s12, 5120
    v_mfma_f32_16x16x32_bf16 v[80:83], v[196:199], v[140:143], v[80:83]
    buffer_load_dwordx4 v[96:99], v10, s[36:39], s58 offen
    s_add_u32 s58, s58, 1024
    v_mfma_f32_16x16x32_bf16 v[84:87], v[200:203], v[140:143], v[84:87]
    buffer_load_dwordx4 v[100:103], v11, s[36:39], s56 offen
    v_mfma_f32_16x16x32_bf16 v[88:91], v[204:207], v[140:143], v[88:91]
    buffer_load_dwordx4 v[104:107], v12, s[36:39], s56 offen
    v_mfma_f32_16x16x32_bf16 v[92:95], v[208:211], v[140:143], v[92:95]
    buffer_load_dwordx4 v[108:111], v13, s[36:39], s56 offen
    s_add_u32 s56, s56, 1024
    s_waitcnt vmcnt(22) lgkmcnt(0)
    v_mfma_f32_16x16x32_bf16 v[16:19], v[212:215], v[144:147], v[16:19]
    ds_read_b128 v[192:195], v9 offset:20480
    v_mfma_f32_16x16x32_bf16 v[20:23], v[216:219], v[144:147], v[20:23]
    ds_read_b128 v[196:199], v9 offset:21504
    v_mfma_f32_16x16x32_bf16 v[24:27], v[220:223], v[144:147], v[24:27]
    ds_read_b128 v[200:203], v9 offset:22528
    v_mfma_f32_16x16x32_bf16 v[28:31], v[224:227], v[144:147], v[28:31]
    ds_read_b128 v[204:207], v9 offset:23552
    v_mfma_f32_16x16x32_bf16 v[32:35], v[228:231], v[144:147], v[32:35]
    ds_read_b128 v[208:211], v9 offset:24576
    v_mfma_f32_16x16x32_bf16 v[36:39], v[212:215], v[148:151], v[36:39]
    s_add_u32 m0, s55, 5120
    s_nop 0
    buffer_load_dwordx4 v8, s[40:43], s8 offen lds
    s_add_u32 s8, s8, 5120
    v_mfma_f32_16x16x32_bf16 v[40:43], v[216:219], v[148:151], v[40:43]
    s_add_u32 m0, s55, 6144
    s_nop 0
    buffer_load_dwordx4 v8, s[40:43], s9 offen lds
    s_add_u32 s9, s9, 5120
    v_mfma_f32_16x16x32_bf16 v[44:47], v[220:223], v[148:151], v[44:47]
    s_add_u32 m0, s55, 7168
    s_nop 0
    buffer_load_dwordx4 v8, s[40:43], s10 offen lds
    s_add_u32 s10, s10, 5120
    v_mfma_f32_16x16x32_bf16 v[48:51], v[224:227], v[148:151], v[48:51]
    s_add_u32 m0, s55, 8192
    s_nop 0
    buffer_load_dwordx4 v8, s[40:43], s11 offen lds
    s_add_u32 s11, s11, 5120
    v_mfma_f32_16x16x32_bf16 v[52:55], v[228:231], v[148:151], v[52:55]
    s_add_u32 m0, s55, 9216
    s_nop 0
    buffer_load_dwordx4 v8, s[40:43], s12 offen lds
    s_add_u32 s12, s12, 5120
    v_mfma_f32_16x16x32_bf16 v[56:59], v[212:215], v[152:155], v[56:59]
    buffer_load_dwordx4 v[112:115], v10, s[36:39], s58 offen
    s_add_u32 s58, s58, 1024
    v_mfma_f32_16x16x32_bf16 v[60:63], v[216:219], v[152:155], v[60:63]
    buffer_load_dwordx4 v[116:119], v11, s[36:39], s56 offen
    v_mfma_f32_16x16x32_bf16 v[64:67], v[220:223], v[152:155], v[64:67]
    buffer_load_dwordx4 v[120:123], v12, s[36:39], s56 offen
    v_mfma_f32_16x16x32_bf16 v[68:71], v[224:227], v[152:155], v[68:71]
    buffer_load_dwordx4 v[124:127], v13, s[36:39], s56 offen
    s_add_u32 s56, s56, 1024
    v_mfma_f32_16x16x32_bf16 v[72:75], v[228:231], v[152:155], v[72:75]
    s_add_u32 m0, s55, 10240
    s_nop 0
    buffer_load_dwordx4 v8, s[40:43], s8 offen lds
    s_add_u32 s8, s8, 5120
    v_mfma_f32_16x16x32_bf16 v[76:79], v[212:215], v[156:159], v[76:79]
    s_add_u32 m0, s55, 11264
    s_nop 0
    buffer_load_dwordx4 v8, s[40:43], s9 offen lds
    s_add_u32 s9, s9, 5120
    v_mfma_f32_16x16x32_bf16 v[80:83], v[216:219], v[156:159], v[80:83]
    s_add_u32 m0, s55, 12288
    s_nop 0
    buffer_load_dwordx4 v8, s[40:43], s10 offen lds
    s_add_u32 s10, s10, 5120
    v_mfma_f32_16x16x32_bf16 v[84:87], v[220:223], v[156:159], v[84:87]
    s_add_u32 m0, s55, 13312
    s_nop 0
    buffer_load_dwordx4 v8, s[40:43], s11 offen lds
    s_add_u32 s11, s11, 5120
    v_mfma_f32_16x16x32_bf16 v[88:91], v[224:227], v[156:159], v[88:91]
    s_add_u32 m0, s55, 14336
    s_nop 0
    buffer_load_dwordx4 v8, s[40:43], s12 offen lds
    s_add_u32 s12, s12, 5120
    v_mfma_f32_16x16x32_bf16 v[92:95], v[228:231], v[156:159], v[92:95]
    buffer_load_dwordx4 v[128:131], v10, s[36:39], s58 offen
    s_add_u32 s58, s58, 1024
    s_waitcnt vmcnt(28) lgkmcnt(0)
    v_mfma_f32_16x16x32_bf16 v[16:19], v[192:195], v[160:163], v[16:19]
    ds_read_b128 v[212:215], v9 offset:25600
    v_mfma_f32_16x16x32_bf16 v[20:23], v[196:199], v[160:163], v[20:23]
    ds_read_b128 v[216:219], v9 offset:26624
    v_mfma_f32_16x16x32_bf16 v[24:27], v[200:203], v[160:163], v[24:27]
    ds_read_b128 v[220:223], v9 offset:27648
    v_mfma_f32_16x16x32_bf16 v[28:31], v[204:207], v[160:163], v[28:31]
    ds_read_b128 v[224:227], v9 offset:28672
    v_mfma_f32_16x16x32_bf16 v[32:35], v[208:211], v[160:163], v[32:35]
    ds_read_b128 v[228:231], v9 offset:29696
    v_mfma_f32_16x16x32_bf16 v[36:39], v[192:195], v[164:167], v[36:39]
    buffer_load_dwordx4 v[132:135], v11, s[36:39], s56 offen
    v_mfma_f32_16x16x32_bf16 v[40:43], v[196:199], v[164:167], v[40:43]
    buffer_load_dwordx4 v[136:139], v12, s[36:39], s56 offen
    v_mfma_f32_16x16x32_bf16 v[44:47], v[200:203], v[164:167], v[44:47]
    buffer_load_dwordx4 v[140:143], v13, s[36:39], s56 offen
    s_add_u32 s56, s56, 1024
    v_mfma_f32_16x16x32_bf16 v[48:51], v[204:207], v[164:167], v[48:51]
    s_add_u32 m0, s55, 15360
    s_nop 0
    buffer_load_dwordx4 v8, s[40:43], s8 offen lds
    s_add_u32 s8, s8, 5120
    v_mfma_f32_16x16x32_bf16 v[52:55], v[208:211], v[164:167], v[52:55]
    s_add_u32 m0, s55, 16384
    s_nop 0
    buffer_load_dwordx4 v8, s[40:43], s9 offen lds
    s_add_u32 s9, s9, 5120
    v_mfma_f32_16x16x32_bf16 v[56:59], v[192:195], v[168:171], v[56:59]
    s_add_u32 m0, s55, 17408
    s_nop 0
    buffer_load_dwordx4 v8, s[40:43], s10 offen lds
    s_add_u32 s10, s10, 5120
    v_mfma_f32_16x16x32_bf16 v[60:63], v[196:199], v[168:171], v[60:63]
    s_add_u32 m0, s55, 18432
    s_nop 0
    buffer_load_dwordx4 v8, s[40:43], s11 offen lds
    s_add_u32 s11, s11, 5120
    v_mfma_f32_16x16x32_bf16 v[64:67], v[200:203], v[168:171], v[64:67]
    s_add_u32 m0, s55, 19456
    s_nop 0
    buffer_load_dwordx4 v8, s[40:43], s12 offen lds
    s_add_u32 s12, s12, 5120
    v_mfma_f32_16x16x32_bf16 v[68:71], v[204:207], v[168:171], v[68:71]
    buffer_load_dwordx4 v[144:147], v10, s[36:39], s58 offen
    s_add_u32 s58, s58, 1024
    v_mfma_f32_16x16x32_bf16 v[72:75], v[208:211], v[168:171], v[72:75]
    buffer_load_dwordx4 v[148:151], v11, s[36:39], s56 offen
    v_mfma_f32_16x16x32_bf16 v[76:79], v[192:195], v[172:175], v[76:79]
    buffer_load_dwordx4 v[152:155], v12, s[36:39], s56 offen
    v_mfma_f32_16x16x32_bf16 v[80:83], v[196:199], v[172:175], v[80:83]
    buffer_load_dwordx4 v[156:159], v13, s[36:39], s56 offen
    s_add_u32 s56, s56, 1024
    v_mfma_f32_16x16x32_bf16 v[84:87], v[200:203], v[172:175], v[84:87]
    s_add_u32 m0, s55, 20480
    s_nop 0
    buffer_load_dwordx4 v8, s[40:43], s8 offen lds
    s_add_u32 s8, s8, 5120
    v_mfma_f32_16x16x32_bf16 v[88:91], v[204:207], v[172:175], v[88:91]
    s_add_u32 m0, s55, 21504
    s_nop 0
    buffer_load_dwordx4 v8, s[40:43], s9 offen lds
    s_add_u32 s9, s9, 5120
    v_mfma_f32_16x16x32_bf16 v[92:95], v[208:211], v[172:175], v[92:95]
    s_add_u32 m0, s55, 22528
    s_nop 0
    buffer_load_dwordx4 v8, s[40:43], s10 offen lds
    s_add_u32 s10, s10, 5120
    s_waitcnt vmcnt(34) lgkmcnt(0)
    v_mfma_f32_16x16x32_bf16 v[16:19], v[212:215], v[176:179], v[16:19]
    ds_read_b128 v[192:195], v9 offset:0
    v_mfma_f32_16x16x32_bf16 v[20:23], v[216:219], v[176:179], v[20:23]
    ds_read_b128 v[196:199], v9 offset:1024
    v_mfma_f32_16x16x32_bf16 v[24:27], v[220:223], v[176:179], v[24:27]
    ds_read_b128 v[200:203], v9 offset:2048
    v_mfma_f32_16x16x32_bf16 v[28:31], v[224:227], v[176:179], v[28:31]
    ds_read_b128 v[204:207], v9 offset:3072
    v_mfma_f32_16x16x32_bf16 v[32:35], v[228:231], v[176:179], v[32:35]
    ds_read_b128 v[208:211], v9 offset:4096
    v_mfma_f32_16x16x32_bf16 v[36:39], v[212:215], v[180:183], v[36:39]
    s_add_u32 m0, s55, 23552
    s_nop 0
    buffer_load_dwordx4 v8, s[40:43], s11 offen lds
    s_add_u32 s11, s11, 5120
    v_mfma_f32_16x16x32_bf16 v[40:43], v[216:219], v[180:183], v[40:43]
    s_add_u32 m0, s55, 24576
    s_nop 0
    buffer_load_dwordx4 v8, s[40:43], s12 offen lds
    s_add_u32 s12, s12, 5120
    v_mfma_f32_16x16x32_bf16 v[44:47], v[220:223], v[180:183], v[44:47]
    buffer_load_dwordx4 v[160:163], v10, s[36:39], s58 offen
    s_add_u32 s58, s58, 1024
    v_mfma_f32_16x16x32_bf16 v[48:51], v[224:227], v[180:183], v[48:51]
    buffer_load_dwordx4 v[164:167], v11, s[36:39], s56 offen
    v_mfma_f32_16x16x32_bf16 v[52:55], v[228:231], v[180:183], v[52:55]
    buffer_load_dwordx4 v[168:171], v12, s[36:39], s56 offen
    v_mfma_f32_16x16x32_bf16 v[56:59], v[212:215], v[184:187], v[56:59]
    buffer_load_dwordx4 v[172:175], v13, s[36:39], s56 offen
    s_add_u32 s56, s56, 1024
    v_mfma_f32_16x16x32_bf16 v[60:63], v[216:219], v[184:187], v[60:63]
    s_add_u32 m0, s55, 25600
    s_nop 0
    buffer_load_dwordx4 v8, s[40:43], s8 offen lds
    s_add_u32 s8, s8, 5120
    v_mfma_f32_16x16x32_bf16 v[64:67], v[220:223], v[184:187], v[64:67]
    s_add_u32 m0, s55, 26624
    s_nop 0
    buffer_load_dwordx4 v8, s[40:43], s9 offen lds
    s_add_u32 s9, s9, 5120
    v_mfma_f32_16x16x32_bf16 v[68:71], v[224:227], v[184:187], v[68:71]
    s_add_u32 m0, s55, 27648
    s_nop 0
    buffer_load_dwordx4 v8, s[40:43], s10 offen lds
    s_add_u32 s10, s10, 5120
    v_mfma_f32_16x16x32_bf16 v[72:75], v[228:231], v[184:187], v[72:75]
    s_add_u32 m0, s55, 28672
    s_nop 0
    buffer_load_dwordx4 v8, s[40:43], s11 offen lds
    s_add_u32 s11, s11, 5120
    v_mfma_f32_16x16x32_bf16 v[76:79], v[212:215], v[188:191], v[76:79]
    s_add_u32 m0, s55, 29696
    s_nop 0
    buffer_load_dwordx4 v8, s[40:43], s12 offen lds
    s_add_u32 s12, s12, 5120
    v_mfma_f32_16x16x32_bf16 v[80:83], v[216:219], v[188:191], v[80:83]
    buffer_load_dwordx4 v[176:179], v10, s[36:39], s58 offen
    s_add_u32 s58, s58, 1024
    v_mfma_f32_16x16x32_bf16 v[84:87], v[220:223], v[188:191], v[84:87]
    buffer_load_dwordx4 v[180:183], v11, s[36:39], s56 offen
    v_mfma_f32_16x16x32_bf16 v[88:91], v[224:227], v[188:191], v[88:91]
    buffer_load_dwordx4 v[184:187], v12, s[36:39], s56 offen
    v_mfma_f32_16x16x32_bf16 v[92:95], v[228:231], v[188:191], v[92:95]
    buffer_load_dwordx4 v[188:191], v13, s[36:39], s56 offen
    s_add_u32 s56, s56, 1024
    s_waitcnt vmcnt(40) lgkmcnt(0)
    v_mfma_f32_16x16x32_bf16 v[16:19], v[192:195], v[96:99], v[16:19]
    ds_read_b128 v[212:215], v9 offset:5120
    v_mfma_f32_16x16x32_bf16 v[20:23], v[196:199], v[96:99], v[20:23]
    ds_read_b128 v[216:219], v9 offset:6144
    v_mfma_f32_16x16x32_bf16 v[24:27], v[200:203], v[96:99], v[24:27]
    ds_read_b128 v[220:223], v9 offset:7168
    v_mfma_f32_16x16x32_bf16 v[28:31], v[204:207], v[96:99], v[28:31]
    ds_read_b128 v[224:227], v9 offset:8192
    v_mfma_f32_16x16x32_bf16 v[32:35], v[208:211], v[96:99], v[32:35]
    ds_read_b128 v[228:231], v9 offset:9216
    v_mfma_f32_16x16x32_bf16 v[36:39], v[192:195], v[100:103], v[36:39]
    v_mfma_f32_16x16x32_bf16 v[40:43], v[196:199], v[100:103], v[40:43]
    v_mfma_f32_16x16x32_bf16 v[44:47], v[200:203], v[100:103], v[44:47]
    v_mfma_f32_16x16x32_bf16 v[48:51], v[204:207], v[100:103], v[48:51]
    v_mfma_f32_16x16x32_bf16 v[52:55], v[208:211], v[100:103], v[52:55]
    v_mfma_f32_16x16x32_bf16 v[56:59], v[192:195], v[104:107], v[56:59]
    v_mfma_f32_16x16x32_bf16 v[60:63], v[196:199], v[104:107], v[60:63]
    v_mfma_f32_16x16x32_bf16 v[64:67], v[200:203], v[104:107], v[64:67]
    v_mfma_f32_16x16x32_bf16 v[68:71], v[204:207], v[104:107], v[68:71]
    v_mfma_f32_16x16x32_bf16 v[72:75], v[208:211], v[104:107], v[72:75]
    v_mfma_f32_16x16x32_bf16 v[76:79], v[192:195], v[108:111], v[76:79]
    v_mfma_f32_16x16x32_bf16 v[80:83], v[196:199], v[108:111], v[80:83]
    v_mfma_f32_16x16x32_bf16 v[84:87], v[200:203], v[108:111], v[84:87]
    v_mfma_f32_16x16x32_bf16 v[88:91], v[204:207], v[108:111], v[88:91]
    v_mfma_f32_16x16x32_bf16 v[92:95], v[208:211], v[108:111], v[92:95]
    s_waitcnt vmcnt(31) lgkmcnt(0)
    v_mfma_f32_16x16x32_bf16 v[16:19], v[212:215], v[112:115], v[16:19]
    ds_read_b128 v[192:195], v9 offset:10240
    v_mfma_f32_16x16x32_bf16 v[20:23], v[216:219], v[112:115], v[20:23]
    ds_read_b128 v[196:199], v9 offset:11264
    v_mfma_f32_16x16x32_bf16 v[24:27], v[220:223], v[112:115], v[24:27]
    ds_read_b128 v[200:203], v9 offset:12288
    v_mfma_f32_16x16x32_bf16 v[28:31], v[224:227], v[112:115], v[28:31]
    ds_read_b128 v[204:207], v9 offset:13312
    v_mfma_f32_16x16x32_bf16 v[32:35], v[228:231], v[112:115], v[32:35]
    ds_read_b128 v[208:211], v9 offset:14336
    v_mfma_f32_16x16x32_bf16 v[36:39], v[212:215], v[116:119], v[36:39]
    v_mfma_f32_16x16x32_bf16 v[40:43], v[216:219], v[116:119], v[40:43]
    v_mfma_f32_16x16x32_bf16 v[44:47], v[220:223], v[116:119], v[44:47]
    v_mfma_f32_16x16x32_bf16 v[48:51], v[224:227], v[116:119], v[48:51]
    v_mfma_f32_16x16x32_bf16 v[52:55], v[228:231], v[116:119], v[52:55]
    v_mfma_f32_16x16x32_bf16 v[56:59], v[212:215], v[120:123], v[56:59]
    v_mfma_f32_16x16x32_bf16 v[60:63], v[216:219], v[120:123], v[60:63]
    v_mfma_f32_16x16x32_bf16 v[64:67], v[220:223], v[120:123], v[64:67]
    v_mfma_f32_16x16x32_bf16 v[68:71], v[224:227], v[120:123], v[68:71]
    v_mfma_f32_16x16x32_bf16 v[72:75], v[228:231], v[120:123], v[72:75]
    v_mfma_f32_16x16x32_bf16 v[76:79], v[212:215], v[124:127], v[76:79]
    v_mfma_f32_16x16x32_bf16 v[80:83], v[216:219], v[124:127], v[80:83]
    v_mfma_f32_16x16x32_bf16 v[84:87], v[220:223], v[124:127], v[84:87]
    v_mfma_f32_16x16x32_bf16 v[88:91], v[224:227], v[124:127], v[88:91]
    v_mfma_f32_16x16x32_bf16 v[92:95], v[228:231], v[124:127], v[92:95]
    s_waitcnt vmcnt(22) lgkmcnt(0)
    v_mfma_f32_16x16x32_bf16 v[16:19], v[192:195], v[128:131], v[16:19]
    ds_read_b128 v[212:215], v9 offset:15360
    v_mfma_f32_16x16x32_bf16 v[20:23], v[196:199], v[128:131], v[20:23]
    ds_read_b128 v[216:219], v9 offset:16384
    v_mfma_f32_16x16x32_bf16 v[24:27], v[200:203], v[128:131], v[24:27]
    ds_read_b128 v[220:223], v9 offset:17408
    v_mfma_f32_16x16x32_bf16 v[28:31], v[204:207], v[128:131], v[28:31]
    ds_read_b128 v[224:227], v9 offset:18432
    v_mfma_f32_16x16x32_bf16 v[32:35], v[208:211], v[128:131], v[32:35]
    ds_read_b128 v[228:231], v9 offset:19456
    v_mfma_f32_16x16x32_bf16 v[36:39], v[192:195], v[132:135], v[36:39]
    v_mfma_f32_16x16x32_bf16 v[40:43], v[196:199], v[132:135], v[40:43]
    v_mfma_f32_16x16x32_bf16 v[44:47], v[200:203], v[132:135], v[44:47]
    v_mfma_f32_16x16x32_bf16 v[48:51], v[204:207], v[132:135], v[48:51]
    v_mfma_f32_16x16x32_bf16 v[52:55], v[208:211], v[132:135], v[52:55]
    v_mfma_f32_16x16x32_bf16 v[56:59], v[192:195], v[136:139], v[56:59]
    v_mfma_f32_16x16x32_bf16 v[60:63], v[196:199], v[136:139], v[60:63]
    v_mfma_f32_16x16x32_bf16 v[64:67], v[200:203], v[136:139], v[64:67]
    v_mfma_f32_16x16x32_bf16 v[68:71], v[204:207], v[136:139], v[68:71]
    v_mfma_f32_16x16x32_bf16 v[72:75], v[208:211], v[136:139], v[72:75]
    v_mfma_f32_16x16x32_bf16 v[76:79], v[192:195], v[140:143], v[76:79]
    v_mfma_f32_16x16x32_bf16 v[80:83], v[196:199], v[140:143], v[80:83]
    v_mfma_f32_16x16x32_bf16 v[84:87], v[200:203], v[140:143], v[84:87]
    v_mfma_f32_16x16x32_bf16 v[88:91], v[204:207], v[140:143], v[88:91]
    v_mfma_f32_16x16x32_bf16 v[92:95], v[208:211], v[140:143], v[92:95]
    s_waitcnt vmcnt(13) lgkmcnt(0)
    s_barrier
    v_mfma_f32_16x16x32_bf16 v[16:19], v[212:215], v[144:147], v[16:19]
    ds_read_b128 v[192:195], v9 offset:20480
    v_mfma_f32_16x16x32_bf16 v[20:23], v[216:219], v[144:147], v[20:23]
    ds_read_b128 v[196:199], v9 offset:21504
    v_mfma_f32_16x16x32_bf16 v[24:27], v[220:223], v[144:147], v[24:27]
    ds_read_b128 v[200:203], v9 offset:22528
    v_mfma_f32_16x16x32_bf16 v[28:31], v[224:227], v[144:147], v[28:31]
    ds_read_b128 v[204:207], v9 offset:23552
    v_mfma_f32_16x16x32_bf16 v[32:35], v[228:231], v[144:147], v[32:35]
    ds_read_b128 v[208:211], v9 offset:24576
    v_mfma_f32_16x16x32_bf16 v[36:39], v[212:215], v[148:151], v[36:39]
    v_mfma_f32_16x16x32_bf16 v[40:43], v[216:219], v[148:151], v[40:43]
    v_mfma_f32_16x16x32_bf16 v[44:47], v[220:223], v[148:151], v[44:47]
    v_mfma_f32_16x16x32_bf16 v[48:51], v[224:227], v[148:151], v[48:51]
    v_mfma_f32_16x16x32_bf16 v[52:55], v[228:231], v[148:151], v[52:55]
    v_mfma_f32_16x16x32_bf16 v[56:59], v[212:215], v[152:155], v[56:59]
    v_mfma_f32_16x16x32_bf16 v[60:63], v[216:219], v[152:155], v[60:63]
    v_mfma_f32_16x16x32_bf16 v[64:67], v[220:223], v[152:155], v[64:67]
    v_mfma_f32_16x16x32_bf16 v[68:71], v[224:227], v[152:155], v[68:71]
    v_mfma_f32_16x16x32_bf16 v[72:75], v[228:231], v[152:155], v[72:75]
    v_mfma_f32_16x16x32_bf16 v[76:79], v[212:215], v[156:159], v[76:79]
    v_mfma_f32_16x16x32_bf16 v[80:83], v[216:219], v[156:159], v[80:83]
    v_mfma_f32_16x16x32_bf16 v[84:87], v[220:223], v[156:159], v[84:87]
    v_mfma_f32_16x16x32_bf16 v[88:91], v[224:227], v[156:159], v[88:91]
    v_mfma_f32_16x16x32_bf16 v[92:95], v[228:231], v[156:159], v[92:95]
    s_waitcnt vmcnt(4) lgkmcnt(0)
    v_mfma_f32_16x16x32_bf16 v[16:19], v[192:195], v[160:163], v[16:19]
    ds_read_b128 v[212:215], v9 offset:25600
    v_mfma_f32_16x16x32_bf16 v[20:23], v[196:199], v[160:163], v[20:23]
    ds_read_b128 v[216:219], v9 offset:26624
    v_mfma_f32_16x16x32_bf16 v[24:27], v[200:203], v[160:163], v[24:27]
    ds_read_b128 v[220:223], v9 offset:27648
    v_mfma_f32_16x16x32_bf16 v[28:31], v[204:207], v[160:163], v[28:31]
    ds_read_b128 v[224:227], v9 offset:28672
    v_mfma_f32_16x16x32_bf16 v[32:35], v[208:211], v[160:163], v[32:35]
    ds_read_b128 v[228:231], v9 offset:29696
    v_mfma_f32_16x16x32_bf16 v[36:39], v[192:195], v[164:167], v[36:39]
    v_mfma_f32_16x16x32_bf16 v[40:43], v[196:199], v[164:167], v[40:43]
    v_mfma_f32_16x16x32_bf16 v[44:47], v[200:203], v[164:167], v[44:47]
    v_mfma_f32_16x16x32_bf16 v[48:51], v[204:207], v[164:167], v[48:51]
    v_mfma_f32_16x16x32_bf16 v[52:55], v[208:211], v[164:167], v[52:55]
    v_mfma_f32_16x16x32_bf16 v[56:59], v[192:195], v[168:171], v[56:59]
    v_mfma_f32_16x16x32_bf16 v[60:63], v[196:199], v[168:171], v[60:63]
    v_mfma_f32_16x16x32_bf16 v[64:67], v[200:203], v[168:171], v[64:67]
    v_mfma_f32_16x16x32_bf16 v[68:71], v[204:207], v[168:171], v[68:71]
    v_mfma_f32_16x16x32_bf16 v[72:75], v[208:211], v[168:171], v[72:75]
    v_mfma_f32_16x16x32_bf16 v[76:79], v[192:195], v[172:175], v[76:79]
    v_mfma_f32_16x16x32_bf16 v[80:83], v[196:199], v[172:175], v[80:83]
    v_mfma_f32_16x16x32_bf16 v[84:87], v[200:203], v[172:175], v[84:87]
    v_mfma_f32_16x16x32_bf16 v[88:91], v[204:207], v[172:175], v[88:91]
    v_mfma_f32_16x16x32_bf16 v[92:95], v[208:211], v[172:175], v[92:95]
    s_waitcnt vmcnt(0) lgkmcnt(0)
    v_mul_u32_u24 v2, 336, v5
    v_lshl_add_u32 v2, v6, 4, v2
    v_add_u32 v2, s55, v2
    v_mfma_f32_16x16x32_bf16 v[16:19], v[212:215], v[176:179], v[16:19]
    v_mfma_f32_16x16x32_bf16 v[20:23], v[216:219], v[176:179], v[20:23]
    v_mfma_f32_16x16x32_bf16 v[24:27], v[220:223], v[176:179], v[24:27]
    v_mfma_f32_16x16x32_bf16 v[28:31], v[224:227], v[176:179], v[28:31]
    v_mfma_f32_16x16x32_bf16 v[32:35], v[228:231], v[176:179], v[32:35]
    v_mfma_f32_16x16x32_bf16 v[36:39], v[212:215], v[180:183], v[36:39]
    v_mfma_f32_16x16x32_bf16 v[40:43], v[216:219], v[180:183], v[40:43]
    v_mfma_f32_16x16x32_bf16 v[44:47], v[220:223], v[180:183], v[44:47]
    v_mfma_f32_16x16x32_bf16 v[48:51], v[224:227], v[180:183], v[48:51]
    v_mfma_f32_16x16x32_bf16 v[52:55], v[228:231], v[180:183], v[52:55]
    ds_write_b128 v2, v[16:19] offset:0
    v_mfma_f32_16x16x32_bf16 v[56:59], v[212:215], v[184:187], v[56:59]
    ds_write_b128 v2, v[20:23] offset:64
    v_mfma_f32_16x16x32_bf16 v[60:63], v[216:219], v[184:187], v[60:63]
    ds_write_b128 v2, v[24:27] offset:128
    v_mfma_f32_16x16x32_bf16 v[64:67], v[220:223], v[184:187], v[64:67]
    ds_write_b128 v2, v[28:31] offset:192
    v_mfma_f32_16x16x32_bf16 v[68:71], v[224:227], v[184:187], v[68:71]
    ds_write_b128 v2, v[32:35] offset:256
    v_mfma_f32_16x16x32_bf16 v[72:75], v[228:231], v[184:187], v[72:75]
    ds_write_b128 v2, v[36:39] offset:5376
    v_mfma_f32_16x16x32_bf16 v[76:79], v[212:215], v[188:191], v[76:79]
    ds_write_b128 v2, v[40:43] offset:5440
    v_mfma_f32_16x16x32_bf16 v[80:83], v[216:219], v[188:191], v[80:83]
    ds_write_b128 v2, v[44:47] offset:5504
    v_mfma_f32_16x16x32_bf16 v[84:87], v[220:223], v[188:191], v[84:87]
    ds_write_b128 v2, v[48:51] offset:5568
    v_mfma_f32_16x16x32_bf16 v[88:91], v[224:227], v[188:191], v[88:91]
    ds_write_b128 v2, v[52:55] offset:5632
    v_mfma_f32_16x16x32_bf16 v[92:95], v[228:231], v[188:191], v[92:95]
    ds_write_b128 v2, v[56:59] offset:10752
    ds_write_b128 v2, v[60:63] offset:10816
    ds_write_b128 v2, v[64:67] offset:10880
    ds_write_b128 v2, v[68:71] offset:10944
    ds_write_b128 v2, v[72:75] offset:11008
    ds_write_b128 v2, v[76:79] offset:16128
    ds_write_b128 v2, v[80:83] offset:16192
    ds_write_b128 v2, v[84:87] offset:16256
    ds_write_b128 v2, v[88:91] offset:16320
    ds_write_b128 v2, v[92:95] offset:16384
    s_waitcnt lgkmcnt(0)
    s_barrier
    s_endpgm
K2_AF:
    s_setprio 3
    s_lshr_b32 s55, s54, 1
    s_and_b32 s56, s54, 1
    s_mul_i32 s56, s56, 5
    s_mul_i32 s5, s52, 83968
    s_mul_i32 s6, s55, 2624
    s_add_u32 s5, s5, s6
    s_lshl_b32 s6, s56, 8
    s_add_u32 s5, s5, s6
    v_mul_u32_u24 v8, 5248, v6
    v_lshl_add_u32 v8, v5, 4, v8
    v_add_u32 v8, s5, v8
    s_mov_b32 s8, 20992
    s_mov_b32 s9, 41984
    s_mov_b32 s10, 62976
    buffer_load_dwordx4 v[44:47], v8, s[44:47], 0 offen offset:2560
    buffer_load_dwordx4 v[48:51], v8, s[44:47], s8 offen offset:2560
    buffer_load_dwordx4 v[52:55], v8, s[44:47], s9 offen offset:2560
    buffer_load_dwordx4 v[56:59], v8, s[44:47], s10 offen offset:2560
    buffer_load_dwordx4 v[12:15], v8, s[44:47], 0 offen offset:0
    buffer_load_dwordx4 v[16:19], v8, s[44:47], s8 offen offset:0
    buffer_load_dwordx4 v[20:23], v8, s[44:47], s9 offen offset:0
    buffer_load_dwordx4 v[24:27], v8, s[44:47], s10 offen offset:0
    buffer_load_dwordx4 v[28:31], v8, s[44:47], 0 offen offset:256
    buffer_load_dwordx4 v[32:35], v8, s[44:47], s8 offen offset:256
    buffer_load_dwordx4 v[36:39], v8, s[44:47], s9 offen offset:256
    buffer_load_dwordx4 v[40:43], v8, s[44:47], s10 offen offset:256
    v_lshlrev_b32 v4, 2, v6
    v_cvt_f32_u32 v4, v4
    s_lshl_b32 s6, s52, 1
    s_add_u32 s5, s6, 0
    v_lshl_add_u32 v125, v5, 6, s5
    v_cvt_f32_u32 v125, v125
    v_mul_f32 v125, 0x3a000000, v125
    v_mul_f32 v124, v4, v125
    v_fmamk_f32 v126, v125, 0x00000000, v124
    v_cos_f32 v128, v126
    v_sin_f32 v129, v126
    v_fmamk_f32 v127, v125, 0x3f800000, v124
    v_cos_f32 v130, v127
    v_sin_f32 v131, v127
    v_fmamk_f32 v126, v125, 0x40000000, v124
    v_cos_f32 v132, v126
    v_sin_f32 v133, v126
    v_fmamk_f32 v127, v125, 0x40400000, v124
    v_cos_f32 v134, v127
    v_sin_f32 v135, v127
    v_cvt_pk_bf16_f32 v60, v128, -v129
    v_cvt_pk_bf16_f32 v64, v129, v128
    v_cvt_pk_bf16_f32 v61, v130, -v131
    v_cvt_pk_bf16_f32 v65, v131, v130
    v_cvt_pk_bf16_f32 v62, v132, -v133
    v_cvt_pk_bf16_f32 v66, v133, v132
    v_cvt_pk_bf16_f32 v63, v134, -v135
    v_cvt_pk_bf16_f32 v67, v135, v134
    v_fmamk_f32 v126, v125, 0x41800000, v124
    v_cos_f32 v128, v126
    v_sin_f32 v129, v126
    v_fmamk_f32 v127, v125, 0x41880000, v124
    v_cos_f32 v130, v127
    v_sin_f32 v131, v127
    v_fmamk_f32 v126, v125, 0x41900000, v124
    v_cos_f32 v132, v126
    v_sin_f32 v133, v126
    v_fmamk_f32 v127, v125, 0x41980000, v124
    v_cos_f32 v134, v127
    v_sin_f32 v135, v127
    v_cvt_pk_bf16_f32 v68, v128, -v129
    v_cvt_pk_bf16_f32 v72, v129, v128
    v_cvt_pk_bf16_f32 v69, v130, -v131
    v_cvt_pk_bf16_f32 v73, v131, v130
    v_cvt_pk_bf16_f32 v70, v132, -v133
    v_cvt_pk_bf16_f32 v74, v133, v132
    v_cvt_pk_bf16_f32 v71, v134, -v135
    v_cvt_pk_bf16_f32 v75, v135, v134
    s_add_u32 s5, s6, 1024
    v_lshl_add_u32 v125, v5, 6, s5
    v_cvt_f32_u32 v125, v125
    v_mul_f32 v125, 0x3a000000, v125
    v_mul_f32 v124, v4, v125
    v_fmamk_f32 v126, v125, 0x00000000, v124
    v_cos_f32 v128, v126
    v_sin_f32 v129, v126
    v_fmamk_f32 v127, v125, 0x3f800000, v124
    v_cos_f32 v130, v127
    v_sin_f32 v131, v127
    v_fmamk_f32 v126, v125, 0x40000000, v124
    v_cos_f32 v132, v126
    v_sin_f32 v133, v126
    v_fmamk_f32 v127, v125, 0x40400000, v124
    v_cos_f32 v134, v127
    v_sin_f32 v135, v127
    v_cvt_pk_bf16_f32 v76, v128, -v129
    v_cvt_pk_bf16_f32 v80, v129, v128
    v_cvt_pk_bf16_f32 v77, v130, -v131
    v_cvt_pk_bf16_f32 v81, v131, v130
    v_cvt_pk_bf16_f32 v78, v132, -v133
    v_cvt_pk_bf16_f32 v82, v133, v132
    v_cvt_pk_bf16_f32 v79, v134, -v135
    v_cvt_pk_bf16_f32 v83, v135, v134
    v_fmamk_f32 v126, v125, 0x41800000, v124
    v_cos_f32 v128, v126
    v_sin_f32 v129, v126
    v_fmamk_f32 v127, v125, 0x41880000, v124
    v_cos_f32 v130, v127
    v_sin_f32 v131, v127
    v_fmamk_f32 v126, v125, 0x41900000, v124
    v_cos_f32 v132, v126
    v_sin_f32 v133, v126
    v_fmamk_f32 v127, v125, 0x41980000, v124
    v_cos_f32 v134, v127
    v_sin_f32 v135, v127
    v_cvt_pk_bf16_f32 v84, v128, -v129
    v_cvt_pk_bf16_f32 v88, v129, v128
    v_cvt_pk_bf16_f32 v85, v130, -v131
    v_cvt_pk_bf16_f32 v89, v131, v130
    v_cvt_pk_bf16_f32 v86, v132, -v133
    v_cvt_pk_bf16_f32 v90, v133, v132
    v_cvt_pk_bf16_f32 v87, v134, -v135
    v_cvt_pk_bf16_f32 v91, v135, v134
    s_add_u32 s5, s6, 1
    v_lshl_add_u32 v125, v5, 6, s5
    v_cvt_f32_u32 v125, v125
    v_mul_f32 v125, 0x3a000000, v125
    v_mul_f32 v124, v4, v125
    v_fmamk_f32 v126, v125, 0x00000000, v124
    v_cos_f32 v128, v126
    v_sin_f32 v129, v126
    v_fmamk_f32 v127, v125, 0x3f800000, v124
    v_cos_f32 v130, v127
    v_sin_f32 v131, v127
    v_fmamk_f32 v126, v125, 0x40000000, v124
    v_cos_f32 v132, v126
    v_sin_f32 v133, v126
    v_fmamk_f32 v127, v125, 0x40400000, v124
    v_cos_f32 v134, v127
    v_sin_f32 v135, v127
    v_cvt_pk_bf16_f32 v92, v128, -v129
    v_cvt_pk_bf16_f32 v96, v129, v128
    v_cvt_pk_bf16_f32 v93, v130, -v131
    v_cvt_pk_bf16_f32 v97, v131, v130
    v_cvt_pk_bf16_f32 v94, v132, -v133
    v_cvt_pk_bf16_f32 v98, v133, v132
    v_cvt_pk_bf16_f32 v95, v134, -v135
    v_cvt_pk_bf16_f32 v99, v135, v134
    v_fmamk_f32 v126, v125, 0x41800000, v124
    v_cos_f32 v128, v126
    v_sin_f32 v129, v126
    v_fmamk_f32 v127, v125, 0x41880000, v124
    v_cos_f32 v130, v127
    v_sin_f32 v131, v127
    v_fmamk_f32 v126, v125, 0x41900000, v124
    v_cos_f32 v132, v126
    v_sin_f32 v133, v126
    v_fmamk_f32 v127, v125, 0x41980000, v124
    v_cos_f32 v134, v127
    v_sin_f32 v135, v127
    v_cvt_pk_bf16_f32 v100, v128, -v129
    v_cvt_pk_bf16_f32 v104, v129, v128
    v_cvt_pk_bf16_f32 v101, v130, -v131
    v_cvt_pk_bf16_f32 v105, v131, v130
    v_cvt_pk_bf16_f32 v102, v132, -v133
    v_cvt_pk_bf16_f32 v106, v133, v132
    v_cvt_pk_bf16_f32 v103, v134, -v135
    v_cvt_pk_bf16_f32 v107, v135, v134
    s_add_u32 s5, s6, 1025
    v_lshl_add_u32 v125, v5, 6, s5
    v_cvt_f32_u32 v125, v125
    v_mul_f32 v125, 0x3a000000, v125
    v_mul_f32 v124, v4, v125
    v_fmamk_f32 v126, v125, 0x00000000, v124
    v_cos_f32 v128, v126
    v_sin_f32 v129, v126
    v_fmamk_f32 v127, v125, 0x3f800000, v124
    v_cos_f32 v130, v127
    v_sin_f32 v131, v127
    v_fmamk_f32 v126, v125, 0x40000000, v124
    v_cos_f32 v132, v126
    v_sin_f32 v133, v126
    v_fmamk_f32 v127, v125, 0x40400000, v124
    v_cos_f32 v134, v127
    v_sin_f32 v135, v127
    v_cvt_pk_bf16_f32 v108, v128, -v129
    v_cvt_pk_bf16_f32 v112, v129, v128
    v_cvt_pk_bf16_f32 v109, v130, -v131
    v_cvt_pk_bf16_f32 v113, v131, v130
    v_cvt_pk_bf16_f32 v110, v132, -v133
    v_cvt_pk_bf16_f32 v114, v133, v132
    v_cvt_pk_bf16_f32 v111, v134, -v135
    v_cvt_pk_bf16_f32 v115, v135, v134
    v_fmamk_f32 v126, v125, 0x41800000, v124
    v_cos_f32 v128, v126
    v_sin_f32 v129, v126
    v_fmamk_f32 v127, v125, 0x41880000, v124
    v_cos_f32 v130, v127
    v_sin_f32 v131, v127
    v_fmamk_f32 v126, v125, 0x41900000, v124
    v_cos_f32 v132, v126
    v_sin_f32 v133, v126
    v_fmamk_f32 v127, v125, 0x41980000, v124
    v_cos_f32 v134, v127
    v_sin_f32 v135, v127
    v_cvt_pk_bf16_f32 v116, v128, -v129
    v_cvt_pk_bf16_f32 v120, v129, v128
    v_cvt_pk_bf16_f32 v117, v130, -v131
    v_cvt_pk_bf16_f32 v121, v131, v130
    v_cvt_pk_bf16_f32 v118, v132, -v133
    v_cvt_pk_bf16_f32 v122, v133, v132
    v_cvt_pk_bf16_f32 v119, v134, -v135
    v_cvt_pk_bf16_f32 v123, v135, v134
    s_lshl_b32 s5, s56, 5
    s_add_u32 s5, s5, s55
    v_lshl_add_u32 v252, v6, 3, s5
    v_cvt_f32_u32 v252, v252
    s_mul_i32 s6, s53, 40
    v_add_u32 v3, s6, v5
    v_cvt_f32_u32 v3, v3
    v_add_f32 v4, 0x00000000, v3
    v_mul_f32 v250, 0x3d4ccccd, v4
    v_fract_f32 v250, v250
    v_cos_f32 v244, v250
    v_sin_f32 v245, v250
    v_add_f32 v251, 0x00000000, v252
    v_mul_f32 v251, v251, v4
    v_mul_f32 v251, 0x3acccccd, v251
    v_fract_f32 v251, v251
    v_cos_f32 v220, v251
    v_sin_f32 v221, v251
    v_add_f32 v251, 0x40000000, v252
    v_mul_f32 v251, v251, v4
    v_mul_f32 v251, 0x3acccccd, v251
    v_fract_f32 v251, v251
    v_cos_f32 v222, v251
    v_sin_f32 v223, v251
    v_add_f32 v251, 0x40800000, v252
    v_mul_f32 v251, v251, v4
    v_mul_f32 v251, 0x3acccccd, v251
    v_fract_f32 v251, v251
    v_cos_f32 v224, v251
    v_sin_f32 v225, v251
    v_add_f32 v251, 0x40c00000, v252
    v_mul_f32 v251, v251, v4
    v_mul_f32 v251, 0x3acccccd, v251
    v_fract_f32 v251, v251
    v_cos_f32 v226, v251
    v_sin_f32 v227, v251
    v_add_f32 v4, 0x41800000, v3
    v_mul_f32 v250, 0x3d4ccccd, v4
    v_fract_f32 v250, v250
    v_cos_f32 v246, v250
    v_sin_f32 v247, v250
    v_add_f32 v251, 0x00000000, v252
    v_mul_f32 v251, v251, v4
    v_mul_f32 v251, 0x3acccccd, v251
    v_fract_f32 v251, v251
    v_cos_f32 v228, v251
    v_sin_f32 v229, v251
    v_add_f32 v251, 0x40000000, v252
    v_mul_f32 v251, v251, v4
    v_mul_f32 v251, 0x3acccccd, v251
    v_fract_f32 v251, v251
    v_cos_f32 v230, v251
    v_sin_f32 v231, v251
    v_add_f32 v251, 0x40800000, v252
    v_mul_f32 v251, v251, v4
    v_mul_f32 v251, 0x3acccccd, v251
    v_fract_f32 v251, v251
    v_cos_f32 v232, v251
    v_sin_f32 v233, v251
    v_add_f32 v251, 0x40c00000, v252
    v_mul_f32 v251, v251, v4
    v_mul_f32 v251, 0x3acccccd, v251
    v_fract_f32 v251, v251
    v_cos_f32 v234, v251
    v_sin_f32 v235, v251
    v_add_f32 v4, 0x42000000, v3
    v_mul_f32 v250, 0x3d4ccccd, v4
    v_fract_f32 v250, v250
    v_cos_f32 v248, v250
    v_sin_f32 v249, v250
    v_add_f32 v251, 0x00000000, v252
    v_mul_f32 v251, v251, v4
    v_mul_f32 v251, 0x3acccccd, v251
    v_fract_f32 v251, v251
    v_cos_f32 v236, v251
    v_sin_f32 v237, v251
    v_add_f32 v251, 0x40000000, v252
    v_mul_f32 v251, v251, v4
    v_mul_f32 v251, 0x3acccccd, v251
    v_fract_f32 v251, v251
    v_cos_f32 v238, v251
    v_sin_f32 v239, v251
    v_add_f32 v251, 0x40800000, v252
    v_mul_f32 v251, v251, v4
    v_mul_f32 v251, 0x3acccccd, v251
    v_fract_f32 v251, v251
    v_cos_f32 v240, v251
    v_sin_f32 v241, v251
    v_add_f32 v251, 0x40c00000, v252
    v_mul_f32 v251, v251, v4
    v_mul_f32 v251, 0x3acccccd, v251
    v_fract_f32 v251, v251
    v_cos_f32 v242, v251
    v_sin_f32 v243, v251
    s_cmp_eq_u32 s54, 0
    s_cbranch_scc0 K2_NONYQ
    s_waitcnt vmcnt(8)
    v_mfma_f32_16x16x32_bf16 v[188:191], v[44:47], v[60:63], 0
    v_mfma_f32_16x16x32_bf16 v[188:191], v[48:51], v[68:71], v[188:191]
    v_mfma_f32_16x16x32_bf16 v[192:195], v[44:47], v[76:79], 0
    v_mfma_f32_16x16x32_bf16 v[192:195], v[48:51], v[84:87], v[192:195]
    v_mfma_f32_16x16x32_bf16 v[196:199], v[52:55], v[92:95], 0
    v_mfma_f32_16x16x32_bf16 v[196:199], v[56:59], v[100:103], v[196:199]
    v_mfma_f32_16x16x32_bf16 v[200:203], v[52:55], v[108:111], 0
    v_mfma_f32_16x16x32_bf16 v[200:203], v[56:59], v[116:119], v[200:203]
    s_nop 1
    v_mul_f32 v216, 0.5, v188
    s_nop 0
    v_mul_f32 v217, 0.5, v192
    s_nop 0
    v_mul_f32 v218, 0.5, v196
    s_nop 0
    v_mul_f32 v219, 0.5, v200
K2_NONYQ:
    s_nop 4
    s_waitcnt vmcnt(8)
    buffer_load_dwordx4 v[44:47], v8, s[44:47], 0 offen offset:512
    buffer_load_dwordx4 v[48:51], v8, s[44:47], s8 offen offset:512
    buffer_load_dwordx4 v[52:55], v8, s[44:47], s9 offen offset:512
    buffer_load_dwordx4 v[56:59], v8, s[44:47], s10 offen offset:512
    v_cmp_gt_u32 s[58:59], 16, v1
    s_cmp_eq_u32 s54, 0
    s_nop 0
    s_cselect_b64 s[58:59], s[58:59], 0
    s_waitcnt vmcnt(8)
    v_mfma_f32_16x16x32_bf16 v[172:175], v[12:15], v[60:63], 0
    v_cvt_pk_bf16_f32 v204, v220, -v221
    v_mfma_f32_16x16x32_bf16 v[176:179], v[12:15], v[64:67], 0
    v_cvt_pk_bf16_f32 v205, v222, -v223
    v_mfma_f32_16x16x32_bf16 v[180:183], v[12:15], v[76:79], 0
    v_cvt_pk_bf16_f32 v206, v224, -v225
    v_mfma_f32_16x16x32_bf16 v[184:187], v[12:15], v[80:83], 0
    v_cvt_pk_bf16_f32 v207, v226, -v227
    v_mfma_f32_16x16x32_bf16 v[172:175], v[16:19], v[68:71], v[172:175]
    v_cvt_pk_bf16_f32 v208, v228, -v229
    v_mfma_f32_16x16x32_bf16 v[176:179], v[16:19], v[72:75], v[176:179]
    v_cvt_pk_bf16_f32 v209, v230, -v231
    v_mfma_f32_16x16x32_bf16 v[180:183], v[16:19], v[84:87], v[180:183]
    v_cvt_pk_bf16_f32 v210, v232, -v233
    v_mfma_f32_16x16x32_bf16 v[184:187], v[16:19], v[88:91], v[184:187]
    v_cvt_pk_bf16_f32 v211, v234, -v235
    s_nop 0
    v_mul_f32 v2, 0.5, v172
    v_cndmask_b32 v172, v172, v2, s[58:59]
    v_cndmask_b32 v176, v176, v216, s[58:59]
    v_cvt_pk_bf16_f32 v188, v172, v176
    v_cvt_pk_bf16_f32 v189, v173, v177
    v_cvt_pk_bf16_f32 v190, v174, v178
    v_cvt_pk_bf16_f32 v191, v175, v179
    v_mul_f32 v2, 0.5, v180
    v_cndmask_b32 v180, v180, v2, s[58:59]
    v_cndmask_b32 v184, v184, v217, s[58:59]
    v_cvt_pk_bf16_f32 v192, v180, v184
    v_cvt_pk_bf16_f32 v193, v181, v185
    v_cvt_pk_bf16_f32 v194, v182, v186
    v_cvt_pk_bf16_f32 v195, v183, v187
    v_mfma_f32_16x16x32_bf16 v[172:175], v[20:23], v[92:95], 0
    v_cvt_pk_bf16_f32 v212, v236, -v237
    v_mfma_f32_16x16x32_bf16 v[176:179], v[20:23], v[96:99], 0
    v_cvt_pk_bf16_f32 v213, v238, -v239
    v_mfma_f32_16x16x32_bf16 v[180:183], v[20:23], v[108:111], 0
    v_cvt_pk_bf16_f32 v214, v240, -v241
    v_mfma_f32_16x16x32_bf16 v[184:187], v[20:23], v[112:115], 0
    v_cvt_pk_bf16_f32 v215, v242, -v243
    v_mfma_f32_16x16x32_bf16 v[172:175], v[24:27], v[100:103], v[172:175]
    v_mfma_f32_16x16x32_bf16 v[176:179], v[24:27], v[104:107], v[176:179]
    v_mfma_f32_16x16x32_bf16 v[180:183], v[24:27], v[116:119], v[180:183]
    v_mfma_f32_16x16x32_bf16 v[184:187], v[24:27], v[120:123], v[184:187]
    s_nop 4
    v_mul_f32 v2, 0.5, v172
    v_cndmask_b32 v172, v172, v2, s[58:59]
    v_cndmask_b32 v176, v176, v218, s[58:59]
    v_cvt_pk_bf16_f32 v196, v172, v176
    v_cvt_pk_bf16_f32 v197, v173, v177
    v_cvt_pk_bf16_f32 v198, v174, v178
    v_cvt_pk_bf16_f32 v199, v175, v179
    v_mul_f32 v2, 0.5, v180
    v_cndmask_b32 v180, v180, v2, s[58:59]
    v_cndmask_b32 v184, v184, v219, s[58:59]
    v_cvt_pk_bf16_f32 v200, v180, v184
    v_cvt_pk_bf16_f32 v201, v181, v185
    v_cvt_pk_bf16_f32 v202, v182, v186
    v_cvt_pk_bf16_f32 v203, v183, v187
    buffer_load_dwordx4 v[12:15], v8, s[44:47], 0 offen offset:768
    buffer_load_dwordx4 v[16:19], v8, s[44:47], s8 offen offset:768
    buffer_load_dwordx4 v[20:23], v8, s[44:47], s9 offen offset:768
    buffer_load_dwordx4 v[24:27], v8, s[44:47], s10 offen offset:768
    v_lshlrev_b32 v2, 31, v5
    v_or_b32 v2, 0x3f803f80, v2
    v_cndmask_b32 v204, v204, v2, s[58:59]
    v_cndmask_b32 v208, v208, v2, s[58:59]
    v_cndmask_b32 v212, v212, v2, s[58:59]
    v_mfma_f32_16x16x32_bf16 v[124:127], v[204:207], v[188:191], 0
    v_mfma_f32_16x16x32_bf16 v[128:131], v[208:211], v[188:191], 0
    v_mfma_f32_16x16x32_bf16 v[132:135], v[212:215], v[188:191], 0
    v_mfma_f32_16x16x32_bf16 v[136:139], v[204:207], v[192:195], 0
    v_mfma_f32_16x16x32_bf16 v[140:143], v[208:211], v[192:195], 0
    v_mfma_f32_16x16x32_bf16 v[144:147], v[212:215], v[192:195], 0
    v_mfma_f32_16x16x32_bf16 v[148:151], v[204:207], v[196:199], 0
    v_mfma_f32_16x16x32_bf16 v[152:155], v[208:211], v[196:199], 0
    v_mfma_f32_16x16x32_bf16 v[156:159], v[212:215], v[196:199], 0
    v_mfma_f32_16x16x32_bf16 v[160:163], v[204:207], v[200:203], 0
    v_mfma_f32_16x16x32_bf16 v[164:167], v[208:211], v[200:203], 0
    v_mfma_f32_16x16x32_bf16 v[168:171], v[212:215], v[200:203], 0
    s_waitcnt vmcnt(8)
    v_mfma_f32_16x16x32_bf16 v[172:175], v[28:31], v[60:63], 0
    v_mul_f32 v250, v221, v245
    v_mul_f32 v221, v221, v244
    v_fmac_f32 v221, v220, v245
    v_fma_f32 v220, v220, v244, -v250
    v_mfma_f32_16x16x32_bf16 v[176:179], v[28:31], v[64:67], 0
    v_mul_f32 v251, v223, v245
    v_mul_f32 v223, v223, v244
    v_fmac_f32 v223, v222, v245
    v_fma_f32 v222, v222, v244, -v251
    v_mfma_f32_16x16x32_bf16 v[180:183], v[28:31], v[76:79], 0
    v_mul_f32 v250, v225, v245
    v_mul_f32 v225, v225, v244
    v_fmac_f32 v225, v224, v245
    v_fma_f32 v224, v224, v244, -v250
    v_mfma_f32_16x16x32_bf16 v[184:187], v[28:31], v[80:83], 0
    v_mul_f32 v251, v227, v245
    v_mul_f32 v227, v227, v244
    v_fmac_f32 v227, v226, v245
    v_fma_f32 v226, v226, v244, -v251
    v_mfma_f32_16x16x32_bf16 v[172:175], v[32:35], v[68:71], v[172:175]
    v_mul_f32 v250, v229, v247
    v_mul_f32 v229, v229, v246
    v_fmac_f32 v229, v228, v247
    v_fma_f32 v228, v228, v246, -v250
    v_mfma_f32_16x16x32_bf16 v[176:179], v[32:35], v[72:75], v[176:179]
    v_mul_f32 v251, v231, v247
    v_mul_f32 v231, v231, v246
    v_fmac_f32 v231, v230, v247
    v_fma_f32 v230, v230, v246, -v251
    v_mfma_f32_16x16x32_bf16 v[180:183], v[32:35], v[84:87], v[180:183]
    v_mul_f32 v250, v233, v247
    v_mul_f32 v233, v233, v246
    v_fmac_f32 v233, v232, v247
    v_fma_f32 v232, v232, v246, -v250
    v_mfma_f32_16x16x32_bf16 v[184:187], v[32:35], v[88:91], v[184:187]
    v_mul_f32 v251, v235, v247
    v_mul_f32 v235, v235, v246
    v_fmac_f32 v235, v234, v247
    v_fma_f32 v234, v234, v246, -v251
    v_cvt_pk_bf16_f32 v188, v172, v176
    v_cvt_pk_bf16_f32 v189, v173, v177
    v_cvt_pk_bf16_f32 v190, v174, v178
    v_cvt_pk_bf16_f32 v191, v175, v179
    v_cvt_pk_bf16_f32 v192, v180, v184
    v_cvt_pk_bf16_f32 v193, v181, v185
    v_cvt_pk_bf16_f32 v194, v182, v186
    v_cvt_pk_bf16_f32 v195, v183, v187
    v_mfma_f32_16x16x32_bf16 v[172:175], v[36:39], v[92:95], 0
    v_mul_f32 v250, v237, v249
    v_mul_f32 v237, v237, v248
    v_fmac_f32 v237, v236, v249
    v_fma_f32 v236, v236, v248, -v250
    v_mfma_f32_16x16x32_bf16 v[176:179], v[36:39], v[96:99], 0
    v_mul_f32 v251, v239, v249
    v_mul_f32 v239, v239, v248
    v_fmac_f32 v239, v238, v249
    v_fma_f32 v238, v238, v248, -v251
    v_mfma_f32_16x16x32_bf16 v[180:183], v[36:39], v[108:111], 0
    v_mul_f32 v250, v241, v249
    v_mul_f32 v241, v241, v248
    v_fmac_f32 v241, v240, v249
    v_fma_f32 v240, v240, v248, -v250
    v_mfma_f32_16x16x32_bf16 v[184:187], v[36:39], v[112:115], 0
    v_mul_f32 v251, v243, v249
    v_mul_f32 v243, v243, v248
    v_fmac_f32 v243, v242, v249
    v_fma_f32 v242, v242, v248, -v251
    v_mfma_f32_16x16x32_bf16 v[172:175], v[40:43], v[100:103], v[172:175]
    v_cvt_pk_bf16_f32 v204, v220, -v221
    v_cvt_pk_bf16_f32 v205, v222, -v223
    v_cvt_pk_bf16_f32 v206, v224, -v225
    v_cvt_pk_bf16_f32 v207, v226, -v227
    v_mfma_f32_16x16x32_bf16 v[176:179], v[40:43], v[104:107], v[176:179]
    v_cvt_pk_bf16_f32 v208, v228, -v229
    v_cvt_pk_bf16_f32 v209, v230, -v231
    v_cvt_pk_bf16_f32 v210, v232, -v233
    v_cvt_pk_bf16_f32 v211, v234, -v235
    v_mfma_f32_16x16x32_bf16 v[180:183], v[40:43], v[116:119], v[180:183]
    v_cvt_pk_bf16_f32 v212, v236, -v237
    v_cvt_pk_bf16_f32 v213, v238, -v239
    v_cvt_pk_bf16_f32 v214, v240, -v241
    v_cvt_pk_bf16_f32 v215, v242, -v243
    v_mfma_f32_16x16x32_bf16 v[184:187], v[40:43], v[120:123], v[184:187]
    v_cvt_pk_bf16_f32 v196, v172, v176
    v_cvt_pk_bf16_f32 v197, v173, v177
    v_cvt_pk_bf16_f32 v198, v174, v178
    v_cvt_pk_bf16_f32 v199, v175, v179
    s_nop 3
    v_cvt_pk_bf16_f32 v200, v180, v184
    v_cvt_pk_bf16_f32 v201, v181, v185
    v_cvt_pk_bf16_f32 v202, v182, v186
    v_cvt_pk_bf16_f32 v203, v183, v187
    buffer_load_dwordx4 v[28:31], v8, s[44:47], 0 offen offset:1024
    buffer_load_dwordx4 v[32:35], v8, s[44:47], s8 offen offset:1024
    buffer_load_dwordx4 v[36:39], v8, s[44:47], s9 offen offset:1024
    buffer_load_dwordx4 v[40:43], v8, s[44:47], s10 offen offset:1024
    v_mfma_f32_16x16x32_bf16 v[124:127], v[204:207], v[188:191], v[124:127]
    v_mfma_f32_16x16x32_bf16 v[128:131], v[208:211], v[188:191], v[128:131]
    v_mfma_f32_16x16x32_bf16 v[132:135], v[212:215], v[188:191], v[132:135]
    v_mfma_f32_16x16x32_bf16 v[136:139], v[204:207], v[192:195], v[136:139]
    v_mfma_f32_16x16x32_bf16 v[140:143], v[208:211], v[192:195], v[140:143]
    v_mfma_f32_16x16x32_bf16 v[144:147], v[212:215], v[192:195], v[144:147]
    v_mfma_f32_16x16x32_bf16 v[148:151], v[204:207], v[196:199], v[148:151]
    v_mfma_f32_16x16x32_bf16 v[152:155], v[208:211], v[196:199], v[152:155]
    v_mfma_f32_16x16x32_bf16 v[156:159], v[212:215], v[196:199], v[156:159]
    v_mfma_f32_16x16x32_bf16 v[160:163], v[204:207], v[200:203], v[160:163]
    v_mfma_f32_16x16x32_bf16 v[164:167], v[208:211], v[200:203], v[164:167]
    v_mfma_f32_16x16x32_bf16 v[168:171], v[212:215], v[200:203], v[168:171]
    s_waitcnt vmcnt(8)
    v_mfma_f32_16x16x32_bf16 v[172:175], v[44:47], v[60:63], 0
    v_mul_f32 v250, v221, v245
    v_mul_f32 v221, v221, v244
    v_fmac_f32 v221, v220, v245
    v_fma_f32 v220, v220, v244, -v250
    v_mfma_f32_16x16x32_bf16 v[176:179], v[44:47], v[64:67], 0
    v_mul_f32 v251, v223, v245
    v_mul_f32 v223, v223, v244
    v_fmac_f32 v223, v222, v245
    v_fma_f32 v222, v222, v244, -v251
    v_mfma_f32_16x16x32_bf16 v[180:183], v[44:47], v[76:79], 0
    v_mul_f32 v250, v225, v245
    v_mul_f32 v225, v225, v244
    v_fmac_f32 v225, v224, v245
    v_fma_f32 v224, v224, v244, -v250
    v_mfma_f32_16x16x32_bf16 v[184:187], v[44:47], v[80:83], 0
    v_mul_f32 v251, v227, v245
    v_mul_f32 v227, v227, v244
    v_fmac_f32 v227, v226, v245
    v_fma_f32 v226, v226, v244, -v251
    v_mfma_f32_16x16x32_bf16 v[172:175], v[48:51], v[68:71], v[172:175]
    v_mul_f32 v250, v229, v247
    v_mul_f32 v229, v229, v246
    v_fmac_f32 v229, v228, v247
    v_fma_f32 v228, v228, v246, -v250
    v_mfma_f32_16x16x32_bf16 v[176:179], v[48:51], v[72:75], v[176:179]
    v_mul_f32 v251, v231, v247
    v_mul_f32 v231, v231, v246
    v_fmac_f32 v231, v230, v247
    v_fma_f32 v230, v230, v246, -v251
    v_mfma_f32_16x16x32_bf16 v[180:183], v[48:51], v[84:87], v[180:183]
    v_mul_f32 v250, v233, v247
    v_mul_f32 v233, v233, v246
    v_fmac_f32 v233, v232, v247
    v_fma_f32 v232, v232, v246, -v250
    v_mfma_f32_16x16x32_bf16 v[184:187], v[48:51], v[88:91], v[184:187]
    v_mul_f32 v251, v235, v247
    v_mul_f32 v235, v235, v246
    v_fmac_f32 v235, v234, v247
    v_fma_f32 v234, v234, v246, -v251
    v_cvt_pk_bf16_f32 v188, v172, v176
    v_cvt_pk_bf16_f32 v189, v173, v177
    v_cvt_pk_bf16_f32 v190, v174, v178
    v_cvt_pk_bf16_f32 v191, v175, v179
    v_cvt_pk_bf16_f32 v192, v180, v184
    v_cvt_pk_bf16_f32 v193, v181, v185
    v_cvt_pk_bf16_f32 v194, v182, v186
    v_cvt_pk_bf16_f32 v195, v183, v187
    v_mfma_f32_16x16x32_bf16 v[172:175], v[52:55], v[92:95], 0
    v_mul_f32 v250, v237, v249
    v_mul_f32 v237, v237, v248
    v_fmac_f32 v237, v236, v249
    v_fma_f32 v236, v236, v248, -v250
    v_mfma_f32_16x16x32_bf16 v[176:179], v[52:55], v[96:99], 0
    v_mul_f32 v251, v239, v249
    v_mul_f32 v239, v239, v248
    v_fmac_f32 v239, v238, v249
    v_fma_f32 v238, v238, v248, -v251
    v_mfma_f32_16x16x32_bf16 v[180:183], v[52:55], v[108:111], 0
    v_mul_f32 v250, v241, v249
    v_mul_f32 v241, v241, v248
    v_fmac_f32 v241, v240, v249
    v_fma_f32 v240, v240, v248, -v250
    v_mfma_f32_16x16x32_bf16 v[184:187], v[52:55], v[112:115], 0
    v_mul_f32 v251, v243, v249
    v_mul_f32 v243, v243, v248
    v_fmac_f32 v243, v242, v249
    v_fma_f32 v242, v242, v248, -v251
    v_mfma_f32_16x16x32_bf16 v[172:175], v[56:59], v[100:103], v[172:175]
    v_cvt_pk_bf16_f32 v204, v220, -v221
    v_cvt_pk_bf16_f32 v205, v222, -v223
    v_cvt_pk_bf16_f32 v206, v224, -v225
    v_cvt_pk_bf16_f32 v207, v226, -v227
    v_mfma_f32_16x16x32_bf16 v[176:179], v[56:59], v[104:107], v[176:179]
    v_cvt_pk_bf16_f32 v208, v228, -v229
    v_cvt_pk_bf16_f32 v209, v230, -v231
    v_cvt_pk_bf16_f32 v210, v232, -v233
    v_cvt_pk_bf16_f32 v211, v234, -v235
    v_mfma_f32_16x16x32_bf16 v[180:183], v[56:59], v[116:119], v[180:183]
    v_cvt_pk_bf16_f32 v212, v236, -v237
    v_cvt_pk_bf16_f32 v213, v238, -v239
    v_cvt_pk_bf16_f32 v214, v240, -v241
    v_cvt_pk_bf16_f32 v215, v242, -v243
    v_mfma_f32_16x16x32_bf16 v[184:187], v[56:59], v[120:123], v[184:187]
    v_cvt_pk_bf16_f32 v196, v172, v176
    v_cvt_pk_bf16_f32 v197, v173, v177
    v_cvt_pk_bf16_f32 v198, v174, v178
    v_cvt_pk_bf16_f32 v199, v175, v179
    s_nop 3
    v_cvt_pk_bf16_f32 v200, v180, v184
    v_cvt_pk_bf16_f32 v201, v181, v185
    v_cvt_pk_bf16_f32 v202, v182, v186
    v_cvt_pk_bf16_f32 v203, v183, v187
    v_mfma_f32_16x16x32_bf16 v[124:127], v[204:207], v[188:191], v[124:127]
    v_mfma_f32_16x16x32_bf16 v[128:131], v[208:211], v[188:191], v[128:131]
    v_mfma_f32_16x16x32_bf16 v[132:135], v[212:215], v[188:191], v[132:135]
    v_mfma_f32_16x16x32_bf16 v[136:139], v[204:207], v[192:195], v[136:139]
    v_mfma_f32_16x16x32_bf16 v[140:143], v[208:211], v[192:195], v[140:143]
    v_mfma_f32_16x16x32_bf16 v[144:147], v[212:215], v[192:195], v[144:147]
    v_mfma_f32_16x16x32_bf16 v[148:151], v[204:207], v[196:199], v[148:151]
    v_mfma_f32_16x16x32_bf16 v[152:155], v[208:211], v[196:199], v[152:155]
    v_mfma_f32_16x16x32_bf16 v[156:159], v[212:215], v[196:199], v[156:159]
    v_mfma_f32_16x16x32_bf16 v[160:163], v[204:207], v[200:203], v[160:163]
    v_mfma_f32_16x16x32_bf16 v[164:167], v[208:211], v[200:203], v[164:167]
    v_mfma_f32_16x16x32_bf16 v[168:171], v[212:215], v[200:203], v[168:171]
    s_waitcnt vmcnt(4)
    v_mfma_f32_16x16x32_bf16 v[172:175], v[12:15], v[60:63], 0
    v_mul_f32 v250, v221, v245
    v_mul_f32 v221, v221, v244
    v_fmac_f32 v221, v220, v245
    v_fma_f32 v220, v220, v244, -v250
    v_mfma_f32_16x16x32_bf16 v[176:179], v[12:15], v[64:67], 0
    v_mul_f32 v251, v223, v245
    v_mul_f32 v223, v223, v244
    v_fmac_f32 v223, v222, v245
    v_fma_f32 v222, v222, v244, -v251
    v_mfma_f32_16x16x32_bf16 v[180:183], v[12:15], v[76:79], 0
    v_mul_f32 v250, v225, v245
    v_mul_f32 v225, v225, v244
    v_fmac_f32 v225, v224, v245
    v_fma_f32 v224, v224, v244, -v250
    v_mfma_f32_16x16x32_bf16 v[184:187], v[12:15], v[80:83], 0
    v_mul_f32 v251, v227, v245
    v_mul_f32 v227, v227, v244
    v_fmac_f32 v227, v226, v245
    v_fma_f32 v226, v226, v244, -v251
    v_mfma_f32_16x16x32_bf16 v[172:175], v[16:19], v[68:71], v[172:175]
    v_mul_f32 v250, v229, v247
    v_mul_f32 v229, v229, v246
    v_fmac_f32 v229, v228, v247
    v_fma_f32 v228, v228, v246, -v250
    v_mfma_f32_16x16x32_bf16 v[176:179], v[16:19], v[72:75], v[176:179]
    v_mul_f32 v251, v231, v247
    v_mul_f32 v231, v231, v246
    v_fmac_f32 v231, v230, v247
    v_fma_f32 v230, v230, v246, -v251
    v_mfma_f32_16x16x32_bf16 v[180:183], v[16:19], v[84:87], v[180:183]
    v_mul_f32 v250, v233, v247
    v_mul_f32 v233, v233, v246
    v_fmac_f32 v233, v232, v247
    v_fma_f32 v232, v232, v246, -v250
    v_mfma_f32_16x16x32_bf16 v[184:187], v[16:19], v[88:91], v[184:187]
    v_mul_f32 v251, v235, v247
    v_mul_f32 v235, v235, v246
    v_fmac_f32 v235, v234, v247
    v_fma_f32 v234, v234, v246, -v251
    v_cvt_pk_bf16_f32 v188, v172, v176
    v_cvt_pk_bf16_f32 v189, v173, v177
    v_cvt_pk_bf16_f32 v190, v174, v178
    v_cvt_pk_bf16_f32 v191, v175, v179
    v_cvt_pk_bf16_f32 v192, v180, v184
    v_cvt_pk_bf16_f32 v193, v181, v185
    v_cvt_pk_bf16_f32 v194, v182, v186
    v_cvt_pk_bf16_f32 v195, v183, v187
    v_mfma_f32_16x16x32_bf16 v[172:175], v[20:23], v[92:95], 0
    v_mul_f32 v250, v237, v249
    v_mul_f32 v237, v237, v248
    v_fmac_f32 v237, v236, v249
    v_fma_f32 v236, v236, v248, -v250
    v_mfma_f32_16x16x32_bf16 v[176:179], v[20:23], v[96:99], 0
    v_mul_f32 v251, v239, v249
    v_mul_f32 v239, v239, v248
    v_fmac_f32 v239, v238, v249
    v_fma_f32 v238, v238, v248, -v251
    v_mfma_f32_16x16x32_bf16 v[180:183], v[20:23], v[108:111], 0
    v_mul_f32 v250, v241, v249
    v_mul_f32 v241, v241, v248
    v_fmac_f32 v241, v240, v249
    v_fma_f32 v240, v240, v248, -v250
    v_mfma_f32_16x16x32_bf16 v[184:187], v[20:23], v[112:115], 0
    v_mul_f32 v251, v243, v249
    v_mul_f32 v243, v243, v248
    v_fmac_f32 v243, v242, v249
    v_fma_f32 v242, v242, v248, -v251
    v_mfma_f32_16x16x32_bf16 v[172:175], v[24:27], v[100:103], v[172:175]
    v_cvt_pk_bf16_f32 v204, v220, -v221
    v_cvt_pk_bf16_f32 v205, v222, -v223
    v_cvt_pk_bf16_f32 v206, v224, -v225
    v_cvt_pk_bf16_f32 v207, v226, -v227
    v_mfma_f32_16x16x32_bf16 v[176:179], v[24:27], v[104:107], v[176:179]
    v_cvt_pk_bf16_f32 v208, v228, -v229
    v_cvt_pk_bf16_f32 v209, v230, -v231
    v_cvt_pk_bf16_f32 v210, v232, -v233
    v_cvt_pk_bf16_f32 v211, v234, -v235
    v_mfma_f32_16x16x32_bf16 v[180:183], v[24:27], v[116:119], v[180:183]
    v_cvt_pk_bf16_f32 v212, v236, -v237
    v_cvt_pk_bf16_f32 v213, v238, -v239
    v_cvt_pk_bf16_f32 v214, v240, -v241
    v_cvt_pk_bf16_f32 v215, v242, -v243
    v_mfma_f32_16x16x32_bf16 v[184:187], v[24:27], v[120:123], v[184:187]
    v_cvt_pk_bf16_f32 v196, v172, v176
    v_cvt_pk_bf16_f32 v197, v173, v177
    v_cvt_pk_bf16_f32 v198, v174, v178
    v_cvt_pk_bf16_f32 v199, v175, v179
    s_nop 3
    v_cvt_pk_bf16_f32 v200, v180, v184
    v_cvt_pk_bf16_f32 v201, v181, v185
    v_cvt_pk_bf16_f32 v202, v182, v186
    v_cvt_pk_bf16_f32 v203, v183, v187
    v_mfma_f32_16x16x32_bf16 v[124:127], v[204:207], v[188:191], v[124:127]
    v_mfma_f32_16x16x32_bf16 v[128:131], v[208:211], v[188:191], v[128:131]
    v_mfma_f32_16x16x32_bf16 v[132:135], v[212:215], v[188:191], v[132:135]
    v_mfma_f32_16x16x32_bf16 v[136:139], v[204:207], v[192:195], v[136:139]
    v_mfma_f32_16x16x32_bf16 v[140:143], v[208:211], v[192:195], v[140:143]
    v_mfma_f32_16x16x32_bf16 v[144:147], v[212:215], v[192:195], v[144:147]
    v_mfma_f32_16x16x32_bf16 v[148:151], v[204:207], v[196:199], v[148:151]
    v_mfma_f32_16x16x32_bf16 v[152:155], v[208:211], v[196:199], v[152:155]
    v_mfma_f32_16x16x32_bf16 v[156:159], v[212:215], v[196:199], v[156:159]
    v_mfma_f32_16x16x32_bf16 v[160:163], v[204:207], v[200:203], v[160:163]
    v_mfma_f32_16x16x32_bf16 v[164:167], v[208:211], v[200:203], v[164:167]
    v_mfma_f32_16x16x32_bf16 v[168:171], v[212:215], v[200:203], v[168:171]
    s_waitcnt vmcnt(0)
    v_mfma_f32_16x16x32_bf16 v[172:175], v[28:31], v[60:63], 0
    v_mul_f32 v250, v221, v245
    v_mul_f32 v221, v221, v244
    v_fmac_f32 v221, v220, v245
    v_fma_f32 v220, v220, v244, -v250
    v_mfma_f32_16x16x32_bf16 v[176:179], v[28:31], v[64:67], 0
    v_mul_f32 v251, v223, v245
    v_mul_f32 v223, v223, v244
    v_fmac_f32 v223, v222, v245
    v_fma_f32 v222, v222, v244, -v251
    v_mfma_f32_16x16x32_bf16 v[180:183], v[28:31], v[76:79], 0
    v_mul_f32 v250, v225, v245
    v_mul_f32 v225, v225, v244
    v_fmac_f32 v225, v224, v245
    v_fma_f32 v224, v224, v244, -v250
    v_mfma_f32_16x16x32_bf16 v[184:187], v[28:31], v[80:83], 0
    v_mul_f32 v251, v227, v245
    v_mul_f32 v227, v227, v244
    v_fmac_f32 v227, v226, v245
    v_fma_f32 v226, v226, v244, -v251
    v_mfma_f32_16x16x32_bf16 v[172:175], v[32:35], v[68:71], v[172:175]
    v_mul_f32 v250, v229, v247
    v_mul_f32 v229, v229, v246
    v_fmac_f32 v229, v228, v247
    v_fma_f32 v228, v228, v246, -v250
    v_mfma_f32_16x16x32_bf16 v[176:179], v[32:35], v[72:75], v[176:179]
    v_mul_f32 v251, v231, v247
    v_mul_f32 v231, v231, v246
    v_fmac_f32 v231, v230, v247
    v_fma_f32 v230, v230, v246, -v251
    v_mfma_f32_16x16x32_bf16 v[180:183], v[32:35], v[84:87], v[180:183]
    v_mul_f32 v250, v233, v247
    v_mul_f32 v233, v233, v246
    v_fmac_f32 v233, v232, v247
    v_fma_f32 v232, v232, v246, -v250
    v_mfma_f32_16x16x32_bf16 v[184:187], v[32:35], v[88:91], v[184:187]
    v_mul_f32 v251, v235, v247
    v_mul_f32 v235, v235, v246
    v_fmac_f32 v235, v234, v247
    v_fma_f32 v234, v234, v246, -v251
    v_cvt_pk_bf16_f32 v188, v172, v176
    v_cvt_pk_bf16_f32 v189, v173, v177
    v_cvt_pk_bf16_f32 v190, v174, v178
    v_cvt_pk_bf16_f32 v191, v175, v179
    v_cvt_pk_bf16_f32 v192, v180, v184
    v_cvt_pk_bf16_f32 v193, v181, v185
    v_cvt_pk_bf16_f32 v194, v182, v186
    v_cvt_pk_bf16_f32 v195, v183, v187
    v_mfma_f32_16x16x32_bf16 v[172:175], v[36:39], v[92:95], 0
    v_mul_f32 v250, v237, v249
    v_mul_f32 v237, v237, v248
    v_fmac_f32 v237, v236, v249
    v_fma_f32 v236, v236, v248, -v250
    v_mfma_f32_16x16x32_bf16 v[176:179], v[36:39], v[96:99], 0
    v_mul_f32 v251, v239, v249
    v_mul_f32 v239, v239, v248
    v_fmac_f32 v239, v238, v249
    v_fma_f32 v238, v238, v248, -v251
    v_mfma_f32_16x16x32_bf16 v[180:183], v[36:39], v[108:111], 0
    v_mul_f32 v250, v241, v249
    v_mul_f32 v241, v241, v248
    v_fmac_f32 v241, v240, v249
    v_fma_f32 v240, v240, v248, -v250
    v_mfma_f32_16x16x32_bf16 v[184:187], v[36:39], v[112:115], 0
    v_mul_f32 v251, v243, v249
    v_mul_f32 v243, v243, v248
    v_fmac_f32 v243, v242, v249
    v_fma_f32 v242, v242, v248, -v251
    v_mfma_f32_16x16x32_bf16 v[172:175], v[40:43], v[100:103], v[172:175]
    v_cvt_pk_bf16_f32 v204, v220, -v221
    v_cvt_pk_bf16_f32 v205, v222, -v223
    v_cvt_pk_bf16_f32 v206, v224, -v225
    v_cvt_pk_bf16_f32 v207, v226, -v227
    v_mfma_f32_16x16x32_bf16 v[176:179], v[40:43], v[104:107], v[176:179]
    v_cvt_pk_bf16_f32 v208, v228, -v229
    v_cvt_pk_bf16_f32 v209, v230, -v231
    v_cvt_pk_bf16_f32 v210, v232, -v233
    v_cvt_pk_bf16_f32 v211, v234, -v235
    v_mfma_f32_16x16x32_bf16 v[180:183], v[40:43], v[116:119], v[180:183]
    v_cvt_pk_bf16_f32 v212, v236, -v237
    v_cvt_pk_bf16_f32 v213, v238, -v239
    v_cvt_pk_bf16_f32 v214, v240, -v241
    v_cvt_pk_bf16_f32 v215, v242, -v243
    v_mfma_f32_16x16x32_bf16 v[184:187], v[40:43], v[120:123], v[184:187]
    v_cvt_pk_bf16_f32 v196, v172, v176
    v_cvt_pk_bf16_f32 v197, v173, v177
    v_cvt_pk_bf16_f32 v198, v174, v178
    v_cvt_pk_bf16_f32 v199, v175, v179
    s_nop 3
    v_cvt_pk_bf16_f32 v200, v180, v184
    v_cvt_pk_bf16_f32 v201, v181, v185
    v_cvt_pk_bf16_f32 v202, v182, v186
    v_cvt_pk_bf16_f32 v203, v183, v187
    v_mfma_f32_16x16x32_bf16 v[124:127], v[204:207], v[188:191], v[124:127]
    v_mfma_f32_16x16x32_bf16 v[128:131], v[208:211], v[188:191], v[128:131]
    v_mfma_f32_16x16x32_bf16 v[132:135], v[212:215], v[188:191], v[132:135]
    v_mfma_f32_16x16x32_bf16 v[136:139], v[204:207], v[192:195], v[136:139]
    v_mfma_f32_16x16x32_bf16 v[140:143], v[208:211], v[192:195], v[140:143]
    v_mfma_f32_16x16x32_bf16 v[144:147], v[212:215], v[192:195], v[144:147]
    v_mfma_f32_16x16x32_bf16 v[148:151], v[204:207], v[196:199], v[148:151]
    v_mfma_f32_16x16x32_bf16 v[152:155], v[208:211], v[196:199], v[152:155]
    v_mfma_f32_16x16x32_bf16 v[156:159], v[212:215], v[196:199], v[156:159]
    v_mfma_f32_16x16x32_bf16 v[160:163], v[204:207], v[200:203], v[160:163]
    v_mfma_f32_16x16x32_bf16 v[164:167], v[208:211], v[200:203], v[164:167]
    v_mfma_f32_16x16x32_bf16 v[168:171], v[212:215], v[200:203], v[168:171]
    s_mul_i32 s5, s54, 10240
    s_add_u32 s5, s5, 122880
    v_mul_u32_u24 v2, 160, v5
    v_lshl_add_u32 v2, v6, 4, v2
    v_add_u32 v2, s5, v2
    ds_write_b128 v2, v[124:127] offset:0
    ds_write_b128 v2, v[128:131] offset:64
    ds_write_b128 v2, v[136:139] offset:2560
    ds_write_b128 v2, v[140:143] offset:2624
    ds_write_b128 v2, v[148:151] offset:5120
    ds_write_b128 v2, v[152:155] offset:5184
    ds_write_b128 v2, v[160:163] offset:7680
    ds_write_b128 v2, v[164:167] offset:7744
    s_mov_b32 exec_hi, 0
    ds_write_b128 v2, v[132:135] offset:128
    ds_write_b128 v2, v[144:147] offset:2688
    ds_write_b128 v2, v[156:159] offset:5248
    ds_write_b128 v2, v[168:171] offset:7808
    s_mov_b64 exec, -1
    s_setprio 0
    s_mov_b32 s8, 6554
    s_mul_i32 s5, s52, 2560
    s_mul_i32 s6, s53, 80
    s_add_u32 s5, s5, s6
    s_mov_b32 s9, 0xffff0000
    s_waitcnt lgkmcnt(0)
    v_add_u32 v2, -256, v0
    v_min_u32 v2, 639, v2
    v_mul_u32_u24 v3, s8, v2
    v_lshrrev_b32 v3, 16, v3
    v_mul_u32_u24 v4, 10, v3
    v_sub_u32 v2, v2, v4
    v_mul_u32_u24 v23, 336, v3
    v_lshl_add_u32 v23, v2, 4, v23
    v_add_u32 v26, 61440, v23
    v_mul_u32_u24 v29, 160, v3
    v_lshl_add_u32 v29, v2, 4, v29
    v_add_u32 v29, 122880, v29
    v_and_b32 v4, 31, v3
    v_lshlrev_b32 v4, 6, v4
    v_lshrrev_b32 v3, 5, v3
    v_add_u32 v4, v4, v3
    v_mul_u32_u24 v4, 1280, v4
    v_lshl_add_u32 v4, v2, 3, v4
    v_add_u32 v20, s5, v4
    buffer_load_dwordx2 v[8:9], v20, s[48:51], 0 offen offset:0
    buffer_load_dwordx2 v[10:11], v20, s[48:51], 0 offen offset:640
    v_add_u32 v2, 0, v0
    v_min_u32 v2, 639, v2
    v_mul_u32_u24 v3, s8, v2
    v_lshrrev_b32 v3, 16, v3
    v_mul_u32_u24 v4, 10, v3
    v_sub_u32 v2, v2, v4
    v_mul_u32_u24 v24, 336, v3
    v_lshl_add_u32 v24, v2, 4, v24
    v_add_u32 v27, 61440, v24
    v_mul_u32_u24 v30, 160, v3
    v_lshl_add_u32 v30, v2, 4, v30
    v_add_u32 v30, 122880, v30
    v_and_b32 v4, 31, v3
    v_lshlrev_b32 v4, 6, v4
    v_lshrrev_b32 v3, 5, v3
    v_add_u32 v4, v4, v3
    v_mul_u32_u24 v4, 1280, v4
    v_lshl_add_u32 v4, v2, 3, v4
    v_add_u32 v21, s5, v4
    buffer_load_dwordx2 v[12:13], v21, s[48:51], 0 offen offset:0
    buffer_load_dwordx2 v[14:15], v21, s[48:51], 0 offen offset:640
    v_add_u32 v2, 256, v0
    v_min_u32 v2, 639, v2
    v_mul_u32_u24 v3, s8, v2
    v_lshrrev_b32 v3, 16, v3
    v_mul_u32_u24 v4, 10, v3
    v_sub_u32 v2, v2, v4
    v_mul_u32_u24 v25, 336, v3
    v_lshl_add_u32 v25, v2, 4, v25
    v_add_u32 v28, 61440, v25
    v_mul_u32_u24 v31, 160, v3
    v_lshl_add_u32 v31, v2, 4, v31
    v_add_u32 v31, 122880, v31
    v_and_b32 v4, 31, v3
    v_lshlrev_b32 v4, 6, v4
    v_lshrrev_b32 v3, 5, v3
    v_add_u32 v4, v4, v3
    v_mul_u32_u24 v4, 1280, v4
    v_lshl_add_u32 v4, v2, 3, v4
    v_add_u32 v22, s5, v4
    buffer_load_dwordx2 v[16:17], v22, s[48:51], 0 offen offset:0
    buffer_load_dwordx2 v[18:19], v22, s[48:51], 0 offen offset:640
    s_barrier
    ds_read_b128 v[32:35], v29 offset:0
    ds_read_b128 v[36:39], v29 offset:10240
    ds_read_b128 v[40:43], v29 offset:20480
    ds_read_b128 v[44:47], v29 offset:30720
    ds_read_b128 v[48:51], v30 offset:0
    ds_read_b128 v[52:55], v30 offset:10240
    ds_read_b128 v[56:59], v30 offset:20480
    ds_read_b128 v[60:63], v30 offset:30720
    ds_read_b128 v[64:67], v31 offset:0
    ds_read_b128 v[68:71], v31 offset:10240
    ds_read_b128 v[72:75], v31 offset:20480
    ds_read_b128 v[76:79], v31 offset:30720
    s_waitcnt vmcnt(0) lgkmcnt(0)
    v_add_f32 v32, v32, v36
    v_add_f32 v40, v40, v44
    v_add_f32 v33, v33, v37
    v_add_f32 v41, v41, v45
    v_add_f32 v34, v34, v38
    v_add_f32 v42, v42, v46
    v_add_f32 v35, v35, v39
    v_add_f32 v43, v43, v47
    v_sub_f32 v36, v32, v40
    v_add_f32 v32, v32, v40
    v_sub_f32 v37, v33, v41
    v_add_f32 v33, v33, v41
    v_sub_f32 v38, v34, v42
    v_add_f32 v34, v34, v42
    v_sub_f32 v39, v35, v43
    v_add_f32 v35, v35, v43
    v_lshlrev_b32 v40, 16, v8
    v_and_b32 v41, s9, v8
    v_lshlrev_b32 v42, 16, v9
    v_and_b32 v43, s9, v9
    v_add_f32 v32, v32, v40
    v_add_f32 v33, v33, v41
    v_add_f32 v34, v34, v42
    v_add_f32 v35, v35, v43
    v_lshlrev_b32 v40, 16, v10
    v_and_b32 v41, s9, v10
    v_lshlrev_b32 v42, 16, v11
    v_and_b32 v43, s9, v11
    v_add_f32 v36, v36, v40
    v_add_f32 v37, v37, v41
    v_add_f32 v38, v38, v42
    v_add_f32 v39, v39, v43
    v_add_f32 v48, v48, v52
    v_add_f32 v56, v56, v60
    v_add_f32 v49, v49, v53
    v_add_f32 v57, v57, v61
    v_add_f32 v50, v50, v54
    v_add_f32 v58, v58, v62
    v_add_f32 v51, v51, v55
    v_add_f32 v59, v59, v63
    v_sub_f32 v52, v48, v56
    v_add_f32 v48, v48, v56
    v_sub_f32 v53, v49, v57
    v_add_f32 v49, v49, v57
    v_sub_f32 v54, v50, v58
    v_add_f32 v50, v50, v58
    v_sub_f32 v55, v51, v59
    v_add_f32 v51, v51, v59
    v_lshlrev_b32 v56, 16, v12
    v_and_b32 v57, s9, v12
    v_lshlrev_b32 v58, 16, v13
    v_and_b32 v59, s9, v13
    v_add_f32 v48, v48, v56
    v_add_f32 v49, v49, v57
    v_add_f32 v50, v50, v58
    v_add_f32 v51, v51, v59
    v_lshlrev_b32 v56, 16, v14
    v_and_b32 v57, s9, v14
    v_lshlrev_b32 v58, 16, v15
    v_and_b32 v59, s9, v15
    v_add_f32 v52, v52, v56
    v_add_f32 v53, v53, v57
    v_add_f32 v54, v54, v58
    v_add_f32 v55, v55, v59
    v_add_f32 v64, v64, v68
    v_add_f32 v72, v72, v76
    v_add_f32 v65, v65, v69
    v_add_f32 v73, v73, v77
    v_add_f32 v66, v66, v70
    v_add_f32 v74, v74, v78
    v_add_f32 v67, v67, v71
    v_add_f32 v75, v75, v79
    v_sub_f32 v68, v64, v72
    v_add_f32 v64, v64, v72
    v_sub_f32 v69, v65, v73
    v_add_f32 v65, v65, v73
    v_sub_f32 v70, v66, v74
    v_add_f32 v66, v66, v74
    v_sub_f32 v71, v67, v75
    v_add_f32 v67, v67, v75
    v_lshlrev_b32 v72, 16, v16
    v_and_b32 v73, s9, v16
    v_lshlrev_b32 v74, 16, v17
    v_and_b32 v75, s9, v17
    v_add_f32 v64, v64, v72
    v_add_f32 v65, v65, v73
    v_add_f32 v66, v66, v74
    v_add_f32 v67, v67, v75
    v_lshlrev_b32 v72, 16, v18
    v_and_b32 v73, s9, v18
    v_lshlrev_b32 v74, 16, v19
    v_and_b32 v75, s9, v19
    v_add_f32 v68, v68, v72
    v_add_f32 v69, v69, v73
    v_add_f32 v70, v70, v74
    v_add_f32 v71, v71, v75
    s_barrier
    ds_read_b128 v[80:83], v23 offset:0
    ds_read_b128 v[84:87], v23 offset:30720
    ds_read_b128 v[88:91], v26 offset:0
    ds_read_b128 v[92:95], v26 offset:30720
    ds_read_b128 v[96:99], v23 offset:160
    ds_read_b128 v[100:103], v23 offset:30880
    ds_read_b128 v[104:107], v26 offset:160
    ds_read_b128 v[108:111], v26 offset:30880
    ds_read_b128 v[112:115], v24 offset:0
    ds_read_b128 v[116:119], v24 offset:30720
    ds_read_b128 v[120:123], v27 offset:0
    ds_read_b128 v[124:127], v27 offset:30720
    ds_read_b128 v[128:131], v24 offset:160
    ds_read_b128 v[132:135], v24 offset:30880
    ds_read_b128 v[136:139], v27 offset:160
    ds_read_b128 v[140:143], v27 offset:30880
    s_waitcnt lgkmcnt(12)
    v_add_f32 v80, v80, v84
    v_add_f32 v88, v88, v92
    v_add_f32 v81, v81, v85
    v_add_f32 v89, v89, v93
    v_add_f32 v82, v82, v86
    v_add_f32 v90, v90, v94
    v_add_f32 v83, v83, v87
    v_add_f32 v91, v91, v95
    v_add_f32 v80, v80, v88
    v_add_f32 v81, v81, v89
    v_add_f32 v82, v82, v90
    v_add_f32 v83, v83, v91
    v_add_f32 v80, v80, v32
    v_add_f32 v81, v81, v33
    v_add_f32 v82, v82, v34
    v_add_f32 v83, v83, v35
    v_cvt_pk_bf16_f32 v84, v80, v81
    v_cvt_pk_bf16_f32 v85, v82, v83
    buffer_store_dwordx2 v[84:85], v20, s[60:63], 0 offen offset:0
    s_waitcnt lgkmcnt(8)
    v_add_f32 v96, v96, v100
    v_add_f32 v104, v104, v108
    v_add_f32 v97, v97, v101
    v_add_f32 v105, v105, v109
    v_add_f32 v98, v98, v102
    v_add_f32 v106, v106, v110
    v_add_f32 v99, v99, v103
    v_add_f32 v107, v107, v111
    v_add_f32 v96, v96, v104
    v_add_f32 v97, v97, v105
    v_add_f32 v98, v98, v106
    v_add_f32 v99, v99, v107
    v_add_f32 v96, v96, v36
    v_add_f32 v97, v97, v37
    v_add_f32 v98, v98, v38
    v_add_f32 v99, v99, v39
    v_cvt_pk_bf16_f32 v100, v96, v97
    v_cvt_pk_bf16_f32 v101, v98, v99
    buffer_store_dwordx2 v[100:101], v20, s[60:63], 0 offen offset:640
    s_cmp_ge_u32 s4, 6
    s_cbranch_scc1 K2_TWO
    ds_read_b128 v[144:147], v25 offset:0
    ds_read_b128 v[148:151], v25 offset:30720
    ds_read_b128 v[152:155], v28 offset:0
    ds_read_b128 v[156:159], v28 offset:30720
    ds_read_b128 v[160:163], v25 offset:160
    ds_read_b128 v[164:167], v25 offset:30880
    ds_read_b128 v[168:171], v28 offset:160
    ds_read_b128 v[172:175], v28 offset:30880
    s_waitcnt lgkmcnt(12)
    v_add_f32 v112, v112, v116
    v_add_f32 v120, v120, v124
    v_add_f32 v113, v113, v117
    v_add_f32 v121, v121, v125
    v_add_f32 v114, v114, v118
    v_add_f32 v122, v122, v126
    v_add_f32 v115, v115, v119
    v_add_f32 v123, v123, v127
    v_add_f32 v112, v112, v120
    v_add_f32 v113, v113, v121
    v_add_f32 v114, v114, v122
    v_add_f32 v115, v115, v123
    v_add_f32 v112, v112, v48
    v_add_f32 v113, v113, v49
    v_add_f32 v114, v114, v50
    v_add_f32 v115, v115, v51
    v_cvt_pk_bf16_f32 v116, v112, v113
    v_cvt_pk_bf16_f32 v117, v114, v115
    buffer_store_dwordx2 v[116:117], v21, s[60:63], 0 offen offset:0
    s_waitcnt lgkmcnt(8)
    v_add_f32 v128, v128, v132
    v_add_f32 v136, v136, v140
    v_add_f32 v129, v129, v133
    v_add_f32 v137, v137, v141
    v_add_f32 v130, v130, v134
    v_add_f32 v138, v138, v142
    v_add_f32 v131, v131, v135
    v_add_f32 v139, v139, v143
    v_add_f32 v128, v128, v136
    v_add_f32 v129, v129, v137
    v_add_f32 v130, v130, v138
    v_add_f32 v131, v131, v139
    v_add_f32 v128, v128, v52
    v_add_f32 v129, v129, v53
    v_add_f32 v130, v130, v54
    v_add_f32 v131, v131, v55
    v_cvt_pk_bf16_f32 v132, v128, v129
    v_cvt_pk_bf16_f32 v133, v130, v131
    buffer_store_dwordx2 v[132:133], v21, s[60:63], 0 offen offset:640
    s_waitcnt lgkmcnt(4)
    v_add_f32 v144, v144, v148
    v_add_f32 v152, v152, v156
    v_add_f32 v145, v145, v149
    v_add_f32 v153, v153, v157
    v_add_f32 v146, v146, v150
    v_add_f32 v154, v154, v158
    v_add_f32 v147, v147, v151
    v_add_f32 v155, v155, v159
    v_add_f32 v144, v144, v152
    v_add_f32 v145, v145, v153
    v_add_f32 v146, v146, v154
    v_add_f32 v147, v147, v155
    v_add_f32 v144, v144, v64
    v_add_f32 v145, v145, v65
    v_add_f32 v146, v146, v66
    v_add_f32 v147, v147, v67
    v_cvt_pk_bf16_f32 v148, v144, v145
    v_cvt_pk_bf16_f32 v149, v146, v147
    buffer_store_dwordx2 v[148:149], v22, s[60:63], 0 offen offset:0
    s_waitcnt lgkmcnt(0)
    v_add_f32 v160, v160, v164
    v_add_f32 v168, v168, v172
    v_add_f32 v161, v161, v165
    v_add_f32 v169, v169, v173
    v_add_f32 v162, v162, v166
    v_add_f32 v170, v170, v174
    v_add_f32 v163, v163, v167
    v_add_f32 v171, v171, v175
    v_add_f32 v160, v160, v168
    v_add_f32 v161, v161, v169
    v_add_f32 v162, v162, v170
    v_add_f32 v163, v163, v171
    v_add_f32 v160, v160, v68
    v_add_f32 v161, v161, v69
    v_add_f32 v162, v162, v70
    v_add_f32 v163, v163, v71
    v_cvt_pk_bf16_f32 v164, v160, v161
    v_cvt_pk_bf16_f32 v165, v162, v163
    buffer_store_dwordx2 v[164:165], v22, s[60:63], 0 offen offset:640
    s_branch K2_DONE
K2_TWO:
    s_waitcnt lgkmcnt(4)
    v_add_f32 v112, v112, v116
    v_add_f32 v120, v120, v124
    v_add_f32 v113, v113, v117
    v_add_f32 v121, v121, v125
    v_add_f32 v114, v114, v118
    v_add_f32 v122, v122, v126
    v_add_f32 v115, v115, v119
    v_add_f32 v123, v123, v127
    v_add_f32 v112, v112, v120
    v_add_f32 v113, v113, v121
    v_add_f32 v114, v114, v122
    v_add_f32 v115, v115, v123
    v_add_f32 v112, v112, v48
    v_add_f32 v113, v113, v49
    v_add_f32 v114, v114, v50
    v_add_f32 v115, v115, v51
    v_cvt_pk_bf16_f32 v116, v112, v113
    v_cvt_pk_bf16_f32 v117, v114, v115
    buffer_store_dwordx2 v[116:117], v21, s[60:63], 0 offen offset:0
    s_waitcnt lgkmcnt(0)
    v_add_f32 v128, v128, v132
    v_add_f32 v136, v136, v140
    v_add_f32 v129, v129, v133
    v_add_f32 v137, v137, v141
    v_add_f32 v130, v130, v134
    v_add_f32 v138, v138, v142
    v_add_f32 v131, v131, v135
    v_add_f32 v139, v139, v143
    v_add_f32 v128, v128, v136
    v_add_f32 v129, v129, v137
    v_add_f32 v130, v130, v138
    v_add_f32 v131, v131, v139
    v_add_f32 v128, v128, v52
    v_add_f32 v129, v129, v53
    v_add_f32 v130, v130, v54
    v_add_f32 v131, v131, v55
    v_cvt_pk_bf16_f32 v132, v128, v129
    v_cvt_pk_bf16_f32 v133, v130, v131
    buffer_store_dwordx2 v[132:133], v21, s[60:63], 0 offen offset:640
K2_DONE:
    s_endpgm
K2_END:
    s_endpgm
CODE_END:
.section .rodata,"a"
.p2align 6
.amdhsa_kernel k1_kernel
  .amdhsa_next_free_vgpr 256
  .amdhsa_next_free_sgpr 96
  .amdhsa_accum_offset 256
  .amdhsa_group_segment_fixed_size 0
  .amdhsa_kernarg_size 80
  .amdhsa_user_sgpr_count 2
  .amdhsa_user_sgpr_kernarg_segment_ptr 1
  .amdhsa_system_sgpr_workgroup_id_x 1
  .amdhsa_system_vgpr_workitem_id 0
.end_amdhsa_kernel
.p2align 6
.amdhsa_kernel k2_kernel
  .amdhsa_next_free_vgpr 256
  .amdhsa_next_free_sgpr 96
  .amdhsa_accum_offset 256
  .amdhsa_group_segment_fixed_size 0
  .amdhsa_kernarg_size 80
  .amdhsa_user_sgpr_count 2
  .amdhsa_user_sgpr_kernarg_segment_ptr 1
  .amdhsa_system_sgpr_workgroup_id_x 1
  .amdhsa_system_vgpr_workitem_id 0
.end_amdhsa_kernel
```
